```python
import torch

def _softmax(x, axis=-1):
    return torch.softmax(x, dim=axis)
def _gelu(x):
    return torch.nn.functional.gelu(x, approximate="tanh")
def _silu(x):
    return torch.nn.functional.silu(x)
def _sigmoid(x):
    return torch.sigmoid(x)
def _layernorm(x, axis=-1, eps=1e-5):
    m = x.mean(dim=axis, keepdim=True)
    v = x.var(dim=axis, keepdim=True, unbiased=False)
    return (x - m) / torch.sqrt(v + eps)
def _scatter_add(tgt, idx, src, axis=0):
    return tgt.clone().index_add_(axis, idx, src)
def _segment_sum(src, seg, n):
    out = torch.zeros((n,) + src.shape[1:], dtype=src.dtype)
    return out.index_add_(0, seg, src)
def _pad(x, pw):
    flat = tuple(v for pair in reversed(pw) for v in pair)
    return torch.nn.functional.pad(x, flat)

kernel_name = 'parallel_sum__ssm_conv_h3__swiglu_ffn__prompt'

def setup_inputs():

    _w = (lambda a: (lambda t: t.to(torch.bfloat16) if t.is_floating_point() else t)(torch.as_tensor(a)))
    def _A_setup():
        B, S, D = 1, 2048, 512
        ks = 4
        return {
            "q": _w((lambda *s: torch.randn(*s, dtype=torch.bfloat16) * 0.05)(B, S, D)),
            "k": _w((lambda *s: torch.randn(*s, dtype=torch.bfloat16) * 0.4)(B, S, D)),
            "v": _w((lambda *s: torch.randn(*s, dtype=torch.bfloat16) * 0.4)(B, S, D)),
            "shift_k": _w((lambda *s: torch.randn(*s, dtype=torch.bfloat16) * 0.4)(D, ks) * 0.5),
            "ssm_k": _w((lambda *s: torch.randn(*s, dtype=torch.bfloat16) * 1.6)(D, S) * (1.0 / S ** 0.5)),
            "ssm_D": _w((lambda *s: torch.randn(*s, dtype=torch.bfloat16) * 0.8)(D)),
        }
    _A_in = _A_setup()

    def _B_setup():
        B, S, D, F = 1, 2048, 512, 1376
        return {
            "x": _w((lambda *s: torch.randn(*s, dtype=torch.bfloat16) * 0.05)(B, S, D)),
            "w_gate": _w((lambda *s: torch.randn(*s, dtype=torch.bfloat16) * 0.05)(D, F)),
            "w_up": _w((lambda *s: torch.randn(*s, dtype=torch.bfloat16) * 0.05)(D, F)),
            "w_down": _w((lambda *s: torch.randn(*s, dtype=torch.bfloat16) * 0.05)(F, D)),
        }
    _B_in = _B_setup()

    return {
        "A_q": _A_in["q"],
        "A_k": _A_in["k"],
        "A_v": _A_in["v"],
        "A_shift_k": _A_in["shift_k"],
        "A_ssm_k": _A_in["ssm_k"],
        "A_ssm_D": _A_in["ssm_D"],
        "B_x": _B_in["x"],
        "B_w_gate": _B_in["w_gate"],
        "B_w_up": _B_in["w_up"],
        "B_w_down": _B_in["w_down"],
    }

def reference(A_q, A_k, A_v, A_shift_k, A_ssm_k, A_ssm_D, B_x, B_w_gate, B_w_up, B_w_down):
    def _A_ref(q, k, v, shift_k, ssm_k, ssm_D):
        B, S, D = q.shape
        ks = shift_k.shape[-1]
        k_pad = _pad(k, ((0, 0), (ks - 1, 0), (0, 0)))
        k_shift = torch.zeros_like(k)
        for t in range(ks):
            k_shift = k_shift + k_pad[:, t:t + S, :] * shift_k[:, ks - 1 - t][None, None, :]
        kv = k_shift * v
        L = 2 * S
        kv_pad = _pad(kv, ((0, 0), (0, S), (0, 0)))
        kf_pad = _pad(ssm_k, ((0, 0), (0, S)))
        kv_f = (lambda x, axes=(-2,-1): torch.fft.rfft2(x.float(), dim=axes))(kv_pad[:, None, :, :], axes=(1, 2))
        kf_f = (lambda x, axes=(-2,-1): torch.fft.rfft2(x.float(), dim=axes))(kf_pad[:, None, :], axes=(1, 2))
        kf_f = (lambda x, *d: x.permute(*d))(kf_f, 1, 2, 0)
        y_f = kv_f * kf_f[None, :, :, :]
        y = (lambda x, s, axes=(-2,-1): torch.fft.irfft2(x, s=s, dim=axes).to(torch.bfloat16))(y_f, (1, L), axes=(1, 2))[:, 0, :S, :]
        y = y + kv * ssm_D[None, None, :]
        return q * y

    def _B_ref(x, w_gate, w_up, w_down):
        g = _silu(x @ w_gate)
        u = x @ w_up
        return (g * u) @ w_down

    x = A_q
    xn = _layernorm(x, axis=-1)
    return x + _A_ref(xn, A_k, A_v, A_shift_k, A_ssm_k, A_ssm_D) + _B_ref(xn, B_w_gate, B_w_up, B_w_down)
```

```asm
; @launch kernel=k1_prep_kernel grid=(1030,1,1) block=(256,1,1) lds=0
; @launch kernel=k2_gemm1_kernel grid=(504,1,1) block=(256,1,1) lds=81920
; @launch kernel=k3_gemm2_kernel grid=(256,1,1) block=(256,1,1) lds=65536
.amdgcn_target "amdgcn-amd-amdhsa--gfx950"
.text
.globl k1_prep_kernel
.p2align 8
.type k1_prep_kernel,@function
k1_prep_kernel:
    s_load_dwordx4 s[4:7], s[0:1], 0
    s_load_dwordx4 s[8:11], s[0:1], 16
    s_load_dwordx4 s[12:15], s[0:1], 56
    s_load_dwordx2 s[16:17], s[0:1], 72
    s_load_dwordx2 s[18:19], s[0:1], 96
    v_lshrrev_b32 v1, 6, v0
    v_and_b32 v63, 63, v0
    s_nop 0
    v_readfirstlane_b32 s20, v1
    s_lshl_b32 s21, s2, 2
    s_add_u32 s20, s20, s21
    s_waitcnt lgkmcnt(0)
    s_cmp_lt_u32 s20, 2048
    s_cbranch_scc1 K1_LN
    s_cmp_lt_u32 s20, 4120
    s_cbranch_scc1 K1_KV
    s_endpgm
K1_LN:
    s_mov_b32 s24, s4
    s_mov_b32 s25, s5
    s_mov_b32 s26, 2097152
    s_mov_b32 s27, 0x00020000
    s_add_u32 s28, s18, 0
    s_addc_u32 s29, s19, 0
    s_mov_b32 s30, 2097152
    s_mov_b32 s31, 0x00020000
    s_lshl_b32 s22, s20, 10
    v_lshlrev_b32 v1, 4, v63
    buffer_load_dwordx4 v[4:7], v1, s[24:27], s22 offen
    s_waitcnt vmcnt(0)
    v_lshlrev_b32 v8, 16, v4
    v_and_b32 v9, 0xffff0000, v4
    v_lshlrev_b32 v10, 16, v5
    v_and_b32 v11, 0xffff0000, v5
    v_lshlrev_b32 v12, 16, v6
    v_and_b32 v13, 0xffff0000, v6
    v_lshlrev_b32 v14, 16, v7
    v_and_b32 v15, 0xffff0000, v7
    v_add_f32 v16, v8, v9
    v_add_f32 v16, v16, v10
    v_add_f32 v16, v16, v11
    v_add_f32 v16, v16, v12
    v_add_f32 v16, v16, v13
    v_add_f32 v16, v16, v14
    v_add_f32 v16, v16, v15
    s_nop 1
    v_add_f32_dpp v16, v16, v16 quad_perm:[1,0,3,2] row_mask:0xf bank_mask:0xf
    s_nop 1
    v_add_f32_dpp v16, v16, v16 quad_perm:[2,3,0,1] row_mask:0xf bank_mask:0xf
    s_nop 1
    v_add_f32_dpp v16, v16, v16 row_half_mirror row_mask:0xf bank_mask:0xf
    s_nop 1
    v_add_f32_dpp v16, v16, v16 row_mirror row_mask:0xf bank_mask:0xf
    s_nop 1
    v_readlane_b32 s40, v16, 0
    v_readlane_b32 s41, v16, 16
    v_readlane_b32 s42, v16, 32
    v_readlane_b32 s43, v16, 48
    s_nop 1
    v_mov_b32 v17, s40
    v_add_f32 v17, s41, v17
    v_add_f32 v17, s42, v17
    v_add_f32 v16, s43, v17
    v_mul_f32 v16, 0x3b000000, v16
    v_sub_f32 v18, v8, v16
    v_mul_f32 v19, v18, v18
    v_sub_f32 v18, v9, v16
    v_fmac_f32 v19, v18, v18
    v_sub_f32 v18, v10, v16
    v_fmac_f32 v19, v18, v18
    v_sub_f32 v18, v11, v16
    v_fmac_f32 v19, v18, v18
    v_sub_f32 v18, v12, v16
    v_fmac_f32 v19, v18, v18
    v_sub_f32 v18, v13, v16
    v_fmac_f32 v19, v18, v18
    v_sub_f32 v18, v14, v16
    v_fmac_f32 v19, v18, v18
    v_sub_f32 v18, v15, v16
    v_fmac_f32 v19, v18, v18
    s_nop 1
    v_add_f32_dpp v19, v19, v19 quad_perm:[1,0,3,2] row_mask:0xf bank_mask:0xf
    s_nop 1
    v_add_f32_dpp v19, v19, v19 quad_perm:[2,3,0,1] row_mask:0xf bank_mask:0xf
    s_nop 1
    v_add_f32_dpp v19, v19, v19 row_half_mirror row_mask:0xf bank_mask:0xf
    s_nop 1
    v_add_f32_dpp v19, v19, v19 row_mirror row_mask:0xf bank_mask:0xf
    s_nop 1
    v_readlane_b32 s40, v19, 0
    v_readlane_b32 s41, v19, 16
    v_readlane_b32 s42, v19, 32
    v_readlane_b32 s43, v19, 48
    s_nop 1
    v_mov_b32 v17, s40
    v_add_f32 v17, s41, v17
    v_add_f32 v17, s42, v17
    v_add_f32 v19, s43, v17
    v_mul_f32 v19, 0x3b000000, v19
    v_cvt_pk_bf16_f32 v19, v19, v19
    v_lshlrev_b32 v19, 16, v19
    v_add_f32 v19, 0x3727c5ac, v19
    v_cvt_pk_bf16_f32 v19, v19, v19
    v_lshlrev_b32 v19, 16, v19
    v_sqrt_f32 v19, v19
    s_nop 0
    v_cvt_pk_bf16_f32 v19, v19, v19
    v_lshlrev_b32 v19, 16, v19
    v_cvt_pk_bf16_f32 v16, v16, v16
    v_lshlrev_b32 v16, 16, v16
    v_rcp_f32 v20, v19
    v_sub_f32 v8, v8, v16
    v_sub_f32 v9, v9, v16
    v_sub_f32 v10, v10, v16
    v_sub_f32 v11, v11, v16
    v_sub_f32 v12, v12, v16
    v_sub_f32 v13, v13, v16
    v_sub_f32 v14, v14, v16
    v_sub_f32 v15, v15, v16
    v_cvt_pk_bf16_f32 v4, v8, v9
    v_cvt_pk_bf16_f32 v5, v10, v11
    v_cvt_pk_bf16_f32 v6, v12, v13
    v_cvt_pk_bf16_f32 v7, v14, v15
    v_lshlrev_b32 v8, 16, v4
    v_and_b32 v9, 0xffff0000, v4
    v_lshlrev_b32 v10, 16, v5
    v_and_b32 v11, 0xffff0000, v5
    v_lshlrev_b32 v12, 16, v6
    v_and_b32 v13, 0xffff0000, v6
    v_lshlrev_b32 v14, 16, v7
    v_and_b32 v15, 0xffff0000, v7
    v_mul_f32 v21, v8, v20
    v_fma_f32 v22, -v21, v19, v8
    v_fma_f32 v8, v22, v20, v21
    v_mul_f32 v21, v9, v20
    v_fma_f32 v22, -v21, v19, v9
    v_fma_f32 v9, v22, v20, v21
    v_mul_f32 v21, v10, v20
    v_fma_f32 v22, -v21, v19, v10
    v_fma_f32 v10, v22, v20, v21
    v_mul_f32 v21, v11, v20
    v_fma_f32 v22, -v21, v19, v11
    v_fma_f32 v11, v22, v20, v21
    v_mul_f32 v21, v12, v20
    v_fma_f32 v22, -v21, v19, v12
    v_fma_f32 v12, v22, v20, v21
    v_mul_f32 v21, v13, v20
    v_fma_f32 v22, -v21, v19, v13
    v_fma_f32 v13, v22, v20, v21
    v_mul_f32 v21, v14, v20
    v_fma_f32 v22, -v21, v19, v14
    v_fma_f32 v14, v22, v20, v21
    v_mul_f32 v21, v15, v20
    v_fma_f32 v22, -v21, v19, v15
    v_fma_f32 v15, v22, v20, v21
    v_cvt_pk_bf16_f32 v4, v8, v9
    v_cvt_pk_bf16_f32 v5, v10, v11
    v_cvt_pk_bf16_f32 v6, v12, v13
    v_cvt_pk_bf16_f32 v7, v14, v15
    s_lshr_b32 s23, s20, 4
    s_lshl_b32 s23, s23, 14
    s_and_b32 s22, s20, 15
    s_lshl_b32 s22, s22, 4
    s_add_u32 s23, s23, s22
    v_lshrrev_b32 v1, 2, v63
    v_lshlrev_b32 v1, 10, v1
    v_and_b32 v2, 3, v63
    v_lshlrev_b32 v2, 8, v2
    v_add_u32 v1, v1, v2
    buffer_store_dwordx4 v[4:7], v1, s[28:31], s23 offen
    s_endpgm
K1_KV:
    s_cmp_ge_u32 s20, 3072
    s_cbranch_scc1 K1_WT
    s_sub_u32 s20, s20, 2048
    s_mov_b32 s24, s6
    s_mov_b32 s25, s7
    s_mov_b32 s26, 2097152
    s_mov_b32 s27, 0x00020000
    s_mov_b32 s28, s8
    s_mov_b32 s29, s9
    s_mov_b32 s30, 2097152
    s_mov_b32 s31, 0x00020000
    s_mov_b32 s32, s10
    s_mov_b32 s33, s11
    s_mov_b32 s34, 4096
    s_mov_b32 s35, 0x00020000
    s_add_u32 s36, s18, 12025856
    s_addc_u32 s37, s19, 0
    s_mov_b32 s38, 2097152
    s_mov_b32 s39, 0x00020000
    s_and_b32 s21, s20, 7
    s_lshr_b32 s22, s20, 3
    s_lshl_b32 s21, s21, 6
    v_and_b32 v1, 31, v63
    v_lshl_add_u32 v1, v1, 1, s21
    v_lshlrev_b32 v2, 3, v1
    buffer_load_dwordx4 v[4:7], v2, s[32:35], 0 offen
    v_lshrrev_b32 v3, 5, v63
    s_lshl_b32 s23, s22, 4
    v_lshl_add_u32 v3, v3, 3, s23
    v_lshlrev_b32 v2, 10, v3
    v_lshl_add_u32 v2, v1, 1, v2
    buffer_load_dword v13, v2, s[24:27], 0 offen offset:0
    buffer_load_dword v14, v2, s[24:27], 0 offen offset:1024
    buffer_load_dword v15, v2, s[24:27], 0 offen offset:2048
    buffer_load_dword v16, v2, s[24:27], 0 offen offset:3072
    v_add_u32 v8, 4096, v2
    buffer_load_dword v17, v8, s[24:27], 0 offen offset:0
    buffer_load_dword v18, v8, s[24:27], 0 offen offset:1024
    buffer_load_dword v19, v8, s[24:27], 0 offen offset:2048
    buffer_load_dword v20, v8, s[24:27], 0 offen offset:3072
    buffer_load_dword v64, v2, s[28:31], 0 offen offset:0
    buffer_load_dword v65, v2, s[28:31], 0 offen offset:1024
    buffer_load_dword v66, v2, s[28:31], 0 offen offset:2048
    buffer_load_dword v67, v2, s[28:31], 0 offen offset:3072
    buffer_load_dword v68, v8, s[28:31], 0 offen offset:0
    buffer_load_dword v69, v8, s[28:31], 0 offen offset:1024
    buffer_load_dword v70, v8, s[28:31], 0 offen offset:2048
    buffer_load_dword v71, v8, s[28:31], 0 offen offset:3072
    v_cmp_eq_u32 vcc, 0, v3
    v_subrev_u32 v9, 3072, v2
    v_cndmask_b32 v9, v9, v2, vcc
    buffer_load_dword v10, v9, s[24:27], 0 offen offset:0
    buffer_load_dword v11, v9, s[24:27], 0 offen offset:1024
    buffer_load_dword v12, v9, s[24:27], 0 offen offset:2048
    s_waitcnt vmcnt(0)
    v_cndmask_b32 v10, v10, 0, vcc
    v_cndmask_b32 v11, v11, 0, vcc
    v_cndmask_b32 v12, v12, 0, vcc
    v_lshlrev_b32 v40, 16, v4
    v_and_b32 v41, 0xffff0000, v4
    v_lshlrev_b32 v42, 16, v5
    v_and_b32 v43, 0xffff0000, v5
    v_lshlrev_b32 v24, 16, v10
    v_lshlrev_b32 v25, 16, v11
    v_lshlrev_b32 v26, 16, v12
    v_lshlrev_b32 v27, 16, v13
    v_lshlrev_b32 v28, 16, v14
    v_lshlrev_b32 v29, 16, v15
    v_lshlrev_b32 v30, 16, v16
    v_lshlrev_b32 v31, 16, v17
    v_lshlrev_b32 v32, 16, v18
    v_lshlrev_b32 v33, 16, v19
    v_lshlrev_b32 v34, 16, v20
    v_lshlrev_b32 v80, 16, v64
    v_lshlrev_b32 v81, 16, v65
    v_lshlrev_b32 v82, 16, v66
    v_lshlrev_b32 v83, 16, v67
    v_lshlrev_b32 v84, 16, v68
    v_lshlrev_b32 v85, 16, v69
    v_lshlrev_b32 v86, 16, v70
    v_lshlrev_b32 v87, 16, v71
    v_mul_f32 v50, v24, v43
    v_mul_f32 v51, v25, v42
    v_mul_f32 v52, v26, v41
    v_mul_f32 v53, v27, v40
    v_cvt_pk_bf16_f32 v50, v50, v51
    v_cvt_pk_bf16_f32 v52, v52, v53
    v_and_b32 v51, 0xffff0000, v50
    v_lshlrev_b32 v50, 16, v50
    v_and_b32 v53, 0xffff0000, v52
    v_lshlrev_b32 v52, 16, v52
    v_add_f32 v50, v50, v51
    v_cvt_pk_bf16_f32 v50, v50, v50
    v_lshlrev_b32 v50, 16, v50
    v_add_f32 v50, v50, v52
    v_cvt_pk_bf16_f32 v50, v50, v50
    v_lshlrev_b32 v50, 16, v50
    v_add_f32 v50, v50, v53
    v_cvt_pk_bf16_f32 v50, v50, v50
    v_lshlrev_b32 v50, 16, v50
    v_mul_f32 v80, v50, v80
    v_mul_f32 v50, v25, v43
    v_mul_f32 v51, v26, v42
    v_mul_f32 v52, v27, v41
    v_mul_f32 v53, v28, v40
    v_cvt_pk_bf16_f32 v50, v50, v51
    v_cvt_pk_bf16_f32 v52, v52, v53
    v_and_b32 v51, 0xffff0000, v50
    v_lshlrev_b32 v50, 16, v50
    v_and_b32 v53, 0xffff0000, v52
    v_lshlrev_b32 v52, 16, v52
    v_add_f32 v50, v50, v51
    v_cvt_pk_bf16_f32 v50, v50, v50
    v_lshlrev_b32 v50, 16, v50
    v_add_f32 v50, v50, v52
    v_cvt_pk_bf16_f32 v50, v50, v50
    v_lshlrev_b32 v50, 16, v50
    v_add_f32 v50, v50, v53
    v_cvt_pk_bf16_f32 v50, v50, v50
    v_lshlrev_b32 v50, 16, v50
    v_mul_f32 v81, v50, v81
    v_mul_f32 v50, v26, v43
    v_mul_f32 v51, v27, v42
    v_mul_f32 v52, v28, v41
    v_mul_f32 v53, v29, v40
    v_cvt_pk_bf16_f32 v50, v50, v51
    v_cvt_pk_bf16_f32 v52, v52, v53
    v_and_b32 v51, 0xffff0000, v50
    v_lshlrev_b32 v50, 16, v50
    v_and_b32 v53, 0xffff0000, v52
    v_lshlrev_b32 v52, 16, v52
    v_add_f32 v50, v50, v51
    v_cvt_pk_bf16_f32 v50, v50, v50
    v_lshlrev_b32 v50, 16, v50
    v_add_f32 v50, v50, v52
    v_cvt_pk_bf16_f32 v50, v50, v50
    v_lshlrev_b32 v50, 16, v50
    v_add_f32 v50, v50, v53
    v_cvt_pk_bf16_f32 v50, v50, v50
    v_lshlrev_b32 v50, 16, v50
    v_mul_f32 v82, v50, v82
    v_mul_f32 v50, v27, v43
    v_mul_f32 v51, v28, v42
    v_mul_f32 v52, v29, v41
    v_mul_f32 v53, v30, v40
    v_cvt_pk_bf16_f32 v50, v50, v51
    v_cvt_pk_bf16_f32 v52, v52, v53
    v_and_b32 v51, 0xffff0000, v50
    v_lshlrev_b32 v50, 16, v50
    v_and_b32 v53, 0xffff0000, v52
    v_lshlrev_b32 v52, 16, v52
    v_add_f32 v50, v50, v51
    v_cvt_pk_bf16_f32 v50, v50, v50
    v_lshlrev_b32 v50, 16, v50
    v_add_f32 v50, v50, v52
    v_cvt_pk_bf16_f32 v50, v50, v50
    v_lshlrev_b32 v50, 16, v50
    v_add_f32 v50, v50, v53
    v_cvt_pk_bf16_f32 v50, v50, v50
    v_lshlrev_b32 v50, 16, v50
    v_mul_f32 v83, v50, v83
    v_mul_f32 v50, v28, v43
    v_mul_f32 v51, v29, v42
    v_mul_f32 v52, v30, v41
    v_mul_f32 v53, v31, v40
    v_cvt_pk_bf16_f32 v50, v50, v51
    v_cvt_pk_bf16_f32 v52, v52, v53
    v_and_b32 v51, 0xffff0000, v50
    v_lshlrev_b32 v50, 16, v50
    v_and_b32 v53, 0xffff0000, v52
    v_lshlrev_b32 v52, 16, v52
    v_add_f32 v50, v50, v51
    v_cvt_pk_bf16_f32 v50, v50, v50
    v_lshlrev_b32 v50, 16, v50
    v_add_f32 v50, v50, v52
    v_cvt_pk_bf16_f32 v50, v50, v50
    v_lshlrev_b32 v50, 16, v50
    v_add_f32 v50, v50, v53
    v_cvt_pk_bf16_f32 v50, v50, v50
    v_lshlrev_b32 v50, 16, v50
    v_mul_f32 v84, v50, v84
    v_mul_f32 v50, v29, v43
    v_mul_f32 v51, v30, v42
    v_mul_f32 v52, v31, v41
    v_mul_f32 v53, v32, v40
    v_cvt_pk_bf16_f32 v50, v50, v51
    v_cvt_pk_bf16_f32 v52, v52, v53
    v_and_b32 v51, 0xffff0000, v50
    v_lshlrev_b32 v50, 16, v50
    v_and_b32 v53, 0xffff0000, v52
    v_lshlrev_b32 v52, 16, v52
    v_add_f32 v50, v50, v51
    v_cvt_pk_bf16_f32 v50, v50, v50
    v_lshlrev_b32 v50, 16, v50
    v_add_f32 v50, v50, v52
    v_cvt_pk_bf16_f32 v50, v50, v50
    v_lshlrev_b32 v50, 16, v50
    v_add_f32 v50, v50, v53
    v_cvt_pk_bf16_f32 v50, v50, v50
    v_lshlrev_b32 v50, 16, v50
    v_mul_f32 v85, v50, v85
    v_mul_f32 v50, v30, v43
    v_mul_f32 v51, v31, v42
    v_mul_f32 v52, v32, v41
    v_mul_f32 v53, v33, v40
    v_cvt_pk_bf16_f32 v50, v50, v51
    v_cvt_pk_bf16_f32 v52, v52, v53
    v_and_b32 v51, 0xffff0000, v50
    v_lshlrev_b32 v50, 16, v50
    v_and_b32 v53, 0xffff0000, v52
    v_lshlrev_b32 v52, 16, v52
    v_add_f32 v50, v50, v51
    v_cvt_pk_bf16_f32 v50, v50, v50
    v_lshlrev_b32 v50, 16, v50
    v_add_f32 v50, v50, v52
    v_cvt_pk_bf16_f32 v50, v50, v50
    v_lshlrev_b32 v50, 16, v50
    v_add_f32 v50, v50, v53
    v_cvt_pk_bf16_f32 v50, v50, v50
    v_lshlrev_b32 v50, 16, v50
    v_mul_f32 v86, v50, v86
    v_mul_f32 v50, v31, v43
    v_mul_f32 v51, v32, v42
    v_mul_f32 v52, v33, v41
    v_mul_f32 v53, v34, v40
    v_cvt_pk_bf16_f32 v50, v50, v51
    v_cvt_pk_bf16_f32 v52, v52, v53
    v_and_b32 v51, 0xffff0000, v50
    v_lshlrev_b32 v50, 16, v50
    v_and_b32 v53, 0xffff0000, v52
    v_lshlrev_b32 v52, 16, v52
    v_add_f32 v50, v50, v51
    v_cvt_pk_bf16_f32 v50, v50, v50
    v_lshlrev_b32 v50, 16, v50
    v_add_f32 v50, v50, v52
    v_cvt_pk_bf16_f32 v50, v50, v50
    v_lshlrev_b32 v50, 16, v50
    v_add_f32 v50, v50, v53
    v_cvt_pk_bf16_f32 v50, v50, v50
    v_lshlrev_b32 v50, 16, v50
    v_mul_f32 v87, v50, v87
    v_cvt_pk_bf16_f32 v100, v87, v86
    v_cvt_pk_bf16_f32 v101, v85, v84
    v_cvt_pk_bf16_f32 v102, v83, v82
    v_cvt_pk_bf16_f32 v103, v81, v80
    v_lshlrev_b32 v40, 16, v6
    v_and_b32 v41, 0xffff0000, v6
    v_lshlrev_b32 v42, 16, v7
    v_and_b32 v43, 0xffff0000, v7
    v_and_b32 v24, 0xffff0000, v10
    v_and_b32 v25, 0xffff0000, v11
    v_and_b32 v26, 0xffff0000, v12
    v_and_b32 v27, 0xffff0000, v13
    v_and_b32 v28, 0xffff0000, v14
    v_and_b32 v29, 0xffff0000, v15
    v_and_b32 v30, 0xffff0000, v16
    v_and_b32 v31, 0xffff0000, v17
    v_and_b32 v32, 0xffff0000, v18
    v_and_b32 v33, 0xffff0000, v19
    v_and_b32 v34, 0xffff0000, v20
    v_and_b32 v80, 0xffff0000, v64
    v_and_b32 v81, 0xffff0000, v65
    v_and_b32 v82, 0xffff0000, v66
    v_and_b32 v83, 0xffff0000, v67
    v_and_b32 v84, 0xffff0000, v68
    v_and_b32 v85, 0xffff0000, v69
    v_and_b32 v86, 0xffff0000, v70
    v_and_b32 v87, 0xffff0000, v71
    v_mul_f32 v50, v24, v43
    v_mul_f32 v51, v25, v42
    v_mul_f32 v52, v26, v41
    v_mul_f32 v53, v27, v40
    v_cvt_pk_bf16_f32 v50, v50, v51
    v_cvt_pk_bf16_f32 v52, v52, v53
    v_and_b32 v51, 0xffff0000, v50
    v_lshlrev_b32 v50, 16, v50
    v_and_b32 v53, 0xffff0000, v52
    v_lshlrev_b32 v52, 16, v52
    v_add_f32 v50, v50, v51
    v_cvt_pk_bf16_f32 v50, v50, v50
    v_lshlrev_b32 v50, 16, v50
    v_add_f32 v50, v50, v52
    v_cvt_pk_bf16_f32 v50, v50, v50
    v_lshlrev_b32 v50, 16, v50
    v_add_f32 v50, v50, v53
    v_cvt_pk_bf16_f32 v50, v50, v50
    v_lshlrev_b32 v50, 16, v50
    v_mul_f32 v80, v50, v80
    v_mul_f32 v50, v25, v43
    v_mul_f32 v51, v26, v42
    v_mul_f32 v52, v27, v41
    v_mul_f32 v53, v28, v40
    v_cvt_pk_bf16_f32 v50, v50, v51
    v_cvt_pk_bf16_f32 v52, v52, v53
    v_and_b32 v51, 0xffff0000, v50
    v_lshlrev_b32 v50, 16, v50
    v_and_b32 v53, 0xffff0000, v52
    v_lshlrev_b32 v52, 16, v52
    v_add_f32 v50, v50, v51
    v_cvt_pk_bf16_f32 v50, v50, v50
    v_lshlrev_b32 v50, 16, v50
    v_add_f32 v50, v50, v52
    v_cvt_pk_bf16_f32 v50, v50, v50
    v_lshlrev_b32 v50, 16, v50
    v_add_f32 v50, v50, v53
    v_cvt_pk_bf16_f32 v50, v50, v50
    v_lshlrev_b32 v50, 16, v50
    v_mul_f32 v81, v50, v81
    v_mul_f32 v50, v26, v43
    v_mul_f32 v51, v27, v42
    v_mul_f32 v52, v28, v41
    v_mul_f32 v53, v29, v40
    v_cvt_pk_bf16_f32 v50, v50, v51
    v_cvt_pk_bf16_f32 v52, v52, v53
    v_and_b32 v51, 0xffff0000, v50
    v_lshlrev_b32 v50, 16, v50
    v_and_b32 v53, 0xffff0000, v52
    v_lshlrev_b32 v52, 16, v52
    v_add_f32 v50, v50, v51
    v_cvt_pk_bf16_f32 v50, v50, v50
    v_lshlrev_b32 v50, 16, v50
    v_add_f32 v50, v50, v52
    v_cvt_pk_bf16_f32 v50, v50, v50
    v_lshlrev_b32 v50, 16, v50
    v_add_f32 v50, v50, v53
    v_cvt_pk_bf16_f32 v50, v50, v50
    v_lshlrev_b32 v50, 16, v50
    v_mul_f32 v82, v50, v82
    v_mul_f32 v50, v27, v43
    v_mul_f32 v51, v28, v42
    v_mul_f32 v52, v29, v41
    v_mul_f32 v53, v30, v40
    v_cvt_pk_bf16_f32 v50, v50, v51
    v_cvt_pk_bf16_f32 v52, v52, v53
    v_and_b32 v51, 0xffff0000, v50
    v_lshlrev_b32 v50, 16, v50
    v_and_b32 v53, 0xffff0000, v52
    v_lshlrev_b32 v52, 16, v52
    v_add_f32 v50, v50, v51
    v_cvt_pk_bf16_f32 v50, v50, v50
    v_lshlrev_b32 v50, 16, v50
    v_add_f32 v50, v50, v52
    v_cvt_pk_bf16_f32 v50, v50, v50
    v_lshlrev_b32 v50, 16, v50
    v_add_f32 v50, v50, v53
    v_cvt_pk_bf16_f32 v50, v50, v50
    v_lshlrev_b32 v50, 16, v50
    v_mul_f32 v83, v50, v83
    v_mul_f32 v50, v28, v43
    v_mul_f32 v51, v29, v42
    v_mul_f32 v52, v30, v41
    v_mul_f32 v53, v31, v40
    v_cvt_pk_bf16_f32 v50, v50, v51
    v_cvt_pk_bf16_f32 v52, v52, v53
    v_and_b32 v51, 0xffff0000, v50
    v_lshlrev_b32 v50, 16, v50
    v_and_b32 v53, 0xffff0000, v52
    v_lshlrev_b32 v52, 16, v52
    v_add_f32 v50, v50, v51
    v_cvt_pk_bf16_f32 v50, v50, v50
    v_lshlrev_b32 v50, 16, v50
    v_add_f32 v50, v50, v52
    v_cvt_pk_bf16_f32 v50, v50, v50
    v_lshlrev_b32 v50, 16, v50
    v_add_f32 v50, v50, v53
    v_cvt_pk_bf16_f32 v50, v50, v50
    v_lshlrev_b32 v50, 16, v50
    v_mul_f32 v84, v50, v84
    v_mul_f32 v50, v29, v43
    v_mul_f32 v51, v30, v42
    v_mul_f32 v52, v31, v41
    v_mul_f32 v53, v32, v40
    v_cvt_pk_bf16_f32 v50, v50, v51
    v_cvt_pk_bf16_f32 v52, v52, v53
    v_and_b32 v51, 0xffff0000, v50
    v_lshlrev_b32 v50, 16, v50
    v_and_b32 v53, 0xffff0000, v52
    v_lshlrev_b32 v52, 16, v52
    v_add_f32 v50, v50, v51
    v_cvt_pk_bf16_f32 v50, v50, v50
    v_lshlrev_b32 v50, 16, v50
    v_add_f32 v50, v50, v52
    v_cvt_pk_bf16_f32 v50, v50, v50
    v_lshlrev_b32 v50, 16, v50
    v_add_f32 v50, v50, v53
    v_cvt_pk_bf16_f32 v50, v50, v50
    v_lshlrev_b32 v50, 16, v50
    v_mul_f32 v85, v50, v85
    v_mul_f32 v50, v30, v43
    v_mul_f32 v51, v31, v42
    v_mul_f32 v52, v32, v41
    v_mul_f32 v53, v33, v40
    v_cvt_pk_bf16_f32 v50, v50, v51
    v_cvt_pk_bf16_f32 v52, v52, v53
    v_and_b32 v51, 0xffff0000, v50
    v_lshlrev_b32 v50, 16, v50
    v_and_b32 v53, 0xffff0000, v52
    v_lshlrev_b32 v52, 16, v52
    v_add_f32 v50, v50, v51
    v_cvt_pk_bf16_f32 v50, v50, v50
    v_lshlrev_b32 v50, 16, v50
    v_add_f32 v50, v50, v52
    v_cvt_pk_bf16_f32 v50, v50, v50
    v_lshlrev_b32 v50, 16, v50
    v_add_f32 v50, v50, v53
    v_cvt_pk_bf16_f32 v50, v50, v50
    v_lshlrev_b32 v50, 16, v50
    v_mul_f32 v86, v50, v86
    v_mul_f32 v50, v31, v43
    v_mul_f32 v51, v32, v42
    v_mul_f32 v52, v33, v41
    v_mul_f32 v53, v34, v40
    v_cvt_pk_bf16_f32 v50, v50, v51
    v_cvt_pk_bf16_f32 v52, v52, v53
    v_and_b32 v51, 0xffff0000, v50
    v_lshlrev_b32 v50, 16, v50
    v_and_b32 v53, 0xffff0000, v52
    v_lshlrev_b32 v52, 16, v52
    v_add_f32 v50, v50, v51
    v_cvt_pk_bf16_f32 v50, v50, v50
    v_lshlrev_b32 v50, 16, v50
    v_add_f32 v50, v50, v52
    v_cvt_pk_bf16_f32 v50, v50, v50
    v_lshlrev_b32 v50, 16, v50
    v_add_f32 v50, v50, v53
    v_cvt_pk_bf16_f32 v50, v50, v50
    v_lshlrev_b32 v50, 16, v50
    v_mul_f32 v87, v50, v87
    v_cvt_pk_bf16_f32 v104, v87, v86
    v_cvt_pk_bf16_f32 v105, v85, v84
    v_cvt_pk_bf16_f32 v106, v83, v82
    v_cvt_pk_bf16_f32 v107, v81, v80
    v_lshlrev_b32 v2, 12, v1
    v_lshlrev_b32 v3, 1, v3
    v_sub_u32 v2, v2, v3
    v_add_u32 v2, 4080, v2
    buffer_store_dwordx4 v[100:103], v2, s[36:39], 0 offen
    v_add_u32 v2, 4096, v2
    buffer_store_dwordx4 v[104:107], v2, s[36:39], 0 offen
    s_endpgm
K1_WT:
    s_sub_u32 s20, s20, 3072
    v_and_b32 v1, 15, v63
    v_lshrrev_b32 v2, 4, v63
    s_cmp_ge_u32 s20, 704
    s_cbranch_scc1 K1_WT_DOWN
    s_cmp_ge_u32 s20, 352
    s_cselect_b32 s48, 1, 0
    s_cselect_b32 s40, s14, s12
    s_cselect_b32 s41, s15, s13
    s_mov_b32 s42, 1409024
    s_mov_b32 s43, 0x00020000
    s_mul_i32 s49, s48, 352
    s_sub_u32 s49, s20, s49
    s_and_b32 s51, s49, 15
    s_lshr_b32 s50, s49, 4
    s_mul_i32 s52, s51, 88064
    s_lshl_b32 s53, s50, 7
    s_add_u32 s52, s52, s53
    s_movk_i32 s45, 0x5600
    v_mul_u32_u24 v4, s45, v2
    v_lshl_add_u32 v4, v1, 3, v4
    s_movk_i32 s45, 2752
    s_mul_i32 s53, s48, 88
    s_lshl_b32 s54, s50, 2
    s_add_u32 s53, s53, s54
    s_lshl_b32 s53, s53, 4
    s_add_u32 s53, s53, s51
    s_lshl_b32 s53, s53, 10
    s_movk_i32 s55, 0x4000
    s_branch K1_WT_GO
K1_WT_DOWN:
    s_sub_u32 s49, s20, 704
    s_mov_b32 s40, s16
    s_mov_b32 s41, s17
    s_mov_b32 s42, 1409024
    s_mov_b32 s43, 0x00020000
    s_lshr_b32 s51, s49, 3
    s_and_b32 s50, s49, 7
    s_lshl_b32 s52, s51, 15
    s_lshl_b32 s53, s50, 7
    s_add_u32 s52, s52, s53
    v_lshlrev_b32 v4, 13, v2
    v_lshl_add_u32 v4, v1, 3, v4
    s_movk_i32 s45, 1024
    s_mul_i32 s53, s50, 172
    s_add_u32 s53, s53, s51
    s_lshl_b32 s53, s53, 10
    s_add_u32 s53, s53, 2883584
    s_mov_b32 s55, 44032
K1_WT_GO:
    s_add_u32 s36, s18, 2097152
    s_addc_u32 s37, s19, 0
    s_mov_b32 s38, 4292608
    s_mov_b32 s39, 0x00020000
    buffer_load_dwordx2 v[10:11], v4, s[40:43], s52 offen
    s_add_u32 s52, s52, s45
    buffer_load_dwordx2 v[12:13], v4, s[40:43], s52 offen
    s_add_u32 s52, s52, s45
    buffer_load_dwordx2 v[14:15], v4, s[40:43], s52 offen
    s_add_u32 s52, s52, s45
    buffer_load_dwordx2 v[16:17], v4, s[40:43], s52 offen
    s_add_u32 s52, s52, s45
    buffer_load_dwordx2 v[18:19], v4, s[40:43], s52 offen
    s_add_u32 s52, s52, s45
    buffer_load_dwordx2 v[20:21], v4, s[40:43], s52 offen
    s_add_u32 s52, s52, s45
    buffer_load_dwordx2 v[22:23], v4, s[40:43], s52 offen
    s_add_u32 s52, s52, s45
    buffer_load_dwordx2 v[24:25], v4, s[40:43], s52 offen
    v_lshrrev_b32 v5, 2, v1
    v_mul_lo_u32 v5, v5, s55
    v_and_b32 v6, 3, v1
    v_lshl_add_u32 v5, v6, 6, v5
    v_lshl_add_u32 v5, v2, 8, v5
    s_mov_b32 s46, 0x05040100
    s_mov_b32 s47, 0x07060302
    s_waitcnt vmcnt(0)
    v_perm_b32 v30, v12, v10, s46
    v_perm_b32 v31, v16, v14, s46
    v_perm_b32 v32, v20, v18, s46
    v_perm_b32 v33, v24, v22, s46
    buffer_store_dwordx4 v[30:33], v5, s[36:39], s53 offen offset:0
    v_perm_b32 v34, v12, v10, s47
    v_perm_b32 v35, v16, v14, s47
    v_perm_b32 v36, v20, v18, s47
    v_perm_b32 v37, v24, v22, s47
    buffer_store_dwordx4 v[34:37], v5, s[36:39], s53 offen offset:16
    v_perm_b32 v38, v13, v11, s46
    v_perm_b32 v39, v17, v15, s46
    v_perm_b32 v40, v21, v19, s46
    v_perm_b32 v41, v25, v23, s46
    buffer_store_dwordx4 v[38:41], v5, s[36:39], s53 offen offset:32
    v_perm_b32 v42, v13, v11, s47
    v_perm_b32 v43, v17, v15, s47
    v_perm_b32 v44, v21, v19, s47
    v_perm_b32 v45, v25, v23, s47
    buffer_store_dwordx4 v[42:45], v5, s[36:39], s53 offen offset:48
K1_WT_END:
    s_endpgm
.section .rodata,"a"
.p2align 6
.amdhsa_kernel k1_prep_kernel
  .amdhsa_next_free_vgpr 112
  .amdhsa_next_free_sgpr 96
  .amdhsa_accum_offset 112
  .amdhsa_group_segment_fixed_size 0
  .amdhsa_kernarg_size 104
  .amdhsa_user_sgpr_count 2
  .amdhsa_user_sgpr_kernarg_segment_ptr 1
  .amdhsa_system_sgpr_workgroup_id_x 1
.end_amdhsa_kernel
.text
.globl k2_gemm1_kernel
.p2align 8
.type k2_gemm1_kernel,@function
k2_gemm1_kernel:
    s_load_dwordx2 s[4:5], s[0:1], 96
    v_lshrrev_b32 v1, 6, v0
    v_and_b32 v63, 63, v0
    s_nop 0
    v_readfirstlane_b32 s30, v1
    s_waitcnt lgkmcnt(0)
    s_cmp_lt_u32 s2, 248
    s_cbranch_scc1 K2_GEMM
K2_CONV:
    s_sub_u32 s20, s2, 248
    s_cmp_ge_u32 s20, 256
    s_cbranch_scc1 K2_END
    s_load_dwordx4 s[24:27], s[0:1], 32
    s_lshr_b32 s21, s30, 1
    s_lshl_b32 s22, s20, 1
    s_add_u32 s22, s22, s21
    s_and_b32 s23, s30, 1
    s_mul_i32 s28, s21, 39936
    s_lshl_b32 s29, s22, 12
    s_waitcnt lgkmcnt(0)
    s_add_u32 s8, s24, s29
    s_addc_u32 s9, s25, 0
    s_mov_b32 s10, 4096
    s_mov_b32 s11, 0x00020000
    s_add_u32 s12, s4, s29
    s_addc_u32 s13, s5, 0
    s_add_u32 s12, s12, 12025856
    s_addc_u32 s13, s13, 0
    s_mov_b32 s14, 4096
    s_mov_b32 s15, 0x00020000
    s_add_u32 s16, s4, s29
    s_addc_u32 s17, s5, 0
    s_add_u32 s16, s16, 14123008
    s_addc_u32 s17, s17, 0
    s_mov_b32 s18, 4096
    s_mov_b32 s19, 0x00020000
    s_mov_b32 s36, s26
    s_mov_b32 s37, s27
    s_mov_b32 s38, 1024
    s_mov_b32 s39, 0x00020000
    s_lshl_b32 s31, s23, 6
    v_add_u32 v1, s31, v63
    v_lshlrev_b32 v2, 4, v1
    buffer_load_dwordx4 v[100:103], v2, s[12:15], 0 offen offset:0
    buffer_load_dwordx4 v[104:107], v2, s[12:15], 0 offen offset:2048
    buffer_load_dwordx4 v[110:113], v2, s[8:11], 0 offen offset:0
    buffer_load_dwordx4 v[114:117], v2, s[8:11], 0 offen offset:4
    buffer_load_dwordx4 v[118:121], v2, s[8:11], 0 offen offset:8
    buffer_load_dwordx4 v[122:125], v2, s[8:11], 0 offen offset:12
    buffer_load_dword v126, v2, s[8:11], 0 offen offset:28
    buffer_load_dwordx4 v[130:133], v2, s[8:11], 0 offen offset:2048
    buffer_load_dwordx4 v[134:137], v2, s[8:11], 0 offen offset:2052
    buffer_load_dwordx4 v[138:141], v2, s[8:11], 0 offen offset:2056
    buffer_load_dwordx4 v[142:145], v2, s[8:11], 0 offen offset:2060
    buffer_load_dword v146, v2, s[8:11], 0 offen offset:2076
    v_mov_b32 v3, 0
    buffer_load_dwordx4 v[150:153], v3, s[8:11], 0 offen
    s_lshl_b32 s31, s22, 1
    v_mov_b32 v3, s31
    buffer_load_ushort v154, v3, s[36:39], 0 offen
    v_mov_b32 v4, 0
    v_mov_b32 v5, 0
    v_mov_b32 v6, 0
    v_mov_b32 v7, 0
    v_lshrrev_b32 v8, 2, v63
    v_and_b32 v8, 7, v8
    v_add_u32 v10, 7, v8
    v_and_b32 v10, 7, v10
    v_lshrrev_b32 v9, 1, v10
    v_lshlrev_b32 v9, 2, v9
    v_and_b32 v10, 1, v10
    v_add_u32 v9, v9, v10
    v_min_u32 v9, 12, v9
    v_lshlrev_b32 v9, 4, v9
    s_movk_i32 s31, 4352
    v_mul_u32_u24 v10, s31, v8
    v_add_u32 v9, v9, v10
    v_and_b32 v10, 3, v63
    v_lshl_add_u32 v9, v10, 4, v9
    v_add_u32 v9, s28, v9
    s_cmp_lg_u32 s23, 0
    s_cbranch_scc1 K2_C_NOZ
    v_cmp_gt_u32 vcc, 32, v63
    s_and_saveexec_b64 s[32:33], vcc
    ds_write_b128 v9, v[4:7]
    s_mov_b64 exec, s[32:33]
    s_branch K2_C_Z2
K2_C_NOZ:
    v_add_u32 v9, 256, v63
    v_bfe_u32 v10, v9, 3, 2
    v_xor_b32 v9, v9, v10
    v_lshlrev_b32 v9, 4, v9
    v_add_u32 v9, s28, v9
    ds_write_b128 v9, v[4:7] offset:34816
K2_C_Z2:
    s_waitcnt vmcnt(0)
    s_cmp_lg_u32 s23, 0
    s_cbranch_scc1 K2_C_NOP
    v_add_u32 v10, 7, v63
    v_and_b32 v10, 7, v10
    v_lshrrev_b32 v9, 1, v10
    v_lshlrev_b32 v9, 2, v9
    v_and_b32 v10, 1, v10
    v_add_u32 v9, v9, v10
    v_min_u32 v9, 12, v9
    v_lshlrev_b32 v9, 4, v9
    s_movk_i32 s31, 4352
    v_mul_u32_u24 v10, s31, v63
    v_add_u32 v9, v9, v10
    v_lshlrev_b32 v10, 1, v63
    v_sub_u32 v9, v9, v10
    v_add_u32 v9, 64, v9
    v_add_u32 v9, s28, v9
    v_cmp_gt_u32 vcc, 8, v63
    s_and_saveexec_b64 s[32:33], vcc
    ds_write_b128 v9, v[150:153]
    s_mov_b64 exec, s[32:33]
K2_C_NOP:
    v_alignbyte_b32 v160, v111, v110, 2
    v_alignbyte_b32 v161, v112, v111, 2
    v_alignbyte_b32 v162, v113, v112, 2
    v_alignbyte_b32 v163, v117, v113, 2
    v_alignbyte_b32 v164, v115, v114, 2
    v_alignbyte_b32 v165, v116, v115, 2
    v_alignbyte_b32 v166, v117, v116, 2
    v_alignbyte_b32 v167, v121, v117, 2
    v_alignbyte_b32 v168, v119, v118, 2
    v_alignbyte_b32 v169, v120, v119, 2
    v_alignbyte_b32 v170, v121, v120, 2
    v_alignbyte_b32 v171, v125, v121, 2
    v_alignbyte_b32 v172, v123, v122, 2
    v_alignbyte_b32 v173, v124, v123, 2
    v_alignbyte_b32 v174, v125, v124, 2
    v_alignbyte_b32 v175, v126, v125, 2
    v_add_u32 v9, s28, v2
    ds_write_b128 v9, v[110:113] offset:256
    ds_write_b128 v9, v[160:163] offset:4416
    ds_write_b128 v9, v[114:117] offset:8784
    ds_write_b128 v9, v[164:167] offset:13184
    ds_write_b128 v9, v[118:121] offset:17552
    ds_write_b128 v9, v[168:171] offset:21952
    ds_write_b128 v9, v[122:125] offset:26320
    ds_write_b128 v9, v[172:175] offset:30720
    v_alignbyte_b32 v160, v131, v130, 2
    v_alignbyte_b32 v161, v132, v131, 2
    v_alignbyte_b32 v162, v133, v132, 2
    v_alignbyte_b32 v163, v137, v133, 2
    v_alignbyte_b32 v164, v135, v134, 2
    v_alignbyte_b32 v165, v136, v135, 2
    v_alignbyte_b32 v166, v137, v136, 2
    v_alignbyte_b32 v167, v141, v137, 2
    v_alignbyte_b32 v168, v139, v138, 2
    v_alignbyte_b32 v169, v140, v139, 2
    v_alignbyte_b32 v170, v141, v140, 2
    v_alignbyte_b32 v171, v145, v141, 2
    v_alignbyte_b32 v172, v143, v142, 2
    v_alignbyte_b32 v173, v144, v143, 2
    v_alignbyte_b32 v174, v145, v144, 2
    v_alignbyte_b32 v175, v146, v145, 2
    v_add_u32 v9, s28, v2
    ds_write_b128 v9, v[130:133] offset:2304
    ds_write_b128 v9, v[160:163] offset:6464
    ds_write_b128 v9, v[134:137] offset:10832
    ds_write_b128 v9, v[164:167] offset:15232
    ds_write_b128 v9, v[138:141] offset:19600
    ds_write_b128 v9, v[168:171] offset:24000
    ds_write_b128 v9, v[142:145] offset:28368
    ds_write_b128 v9, v[172:175] offset:32768
    v_add_u32 v9, 0, v1
    v_bfe_u32 v10, v9, 3, 2
    v_xor_b32 v9, v9, v10
    v_lshlrev_b32 v9, 4, v9
    v_add_u32 v9, s28, v9
    ds_write_b128 v9, v[100:103] offset:34816
    v_add_u32 v9, 128, v1
    v_bfe_u32 v10, v9, 3, 2
    v_xor_b32 v9, v9, v10
    v_lshlrev_b32 v9, 4, v9
    v_add_u32 v9, s28, v9
    ds_write_b128 v9, v[104:107] offset:34816
    v_and_b32 v8, 15, v63
    v_add_u32 v8, 1, v8
    v_and_b32 v11, 7, v8
    v_add_u32 v10, 7, v11
    v_and_b32 v10, 7, v10
    v_lshrrev_b32 v12, 1, v10
    v_lshlrev_b32 v12, 2, v12
    v_and_b32 v10, 1, v10
    v_add_u32 v12, v12, v10
    v_min_u32 v12, 12, v12
    v_lshlrev_b32 v12, 4, v12
    s_movk_i32 s31, 4352
    v_mul_u32_u24 v10, s31, v11
    v_add_u32 v12, v12, v10
    v_lshrrev_b32 v8, 3, v8
    v_lshrrev_b32 v10, 4, v63
    v_add_u32 v8, v8, v10
    v_lshl_add_u32 v12, v8, 4, v12
    v_add_u32 v12, s28, v12
    v_and_b32 v8, 15, v63
    v_lshlrev_b32 v8, 2, v8
    v_sub_u32 v8, v10, v8
    v_add_u32 v8, 252, v8
    s_lshl_b32 s31, s23, 6
    v_subrev_u32 v9, s31, v8
    v_add_u32 v10, 0, v9
    v_bfe_u32 v11, v10, 3, 2
    v_xor_b32 v10, v10, v11
    v_lshlrev_b32 v16, 4, v10
    v_add_u32 v16, s28, v16
    v_add_u32 v10, 4, v9
    v_bfe_u32 v11, v10, 3, 2
    v_xor_b32 v10, v10, v11
    v_lshlrev_b32 v17, 4, v10
    v_add_u32 v17, s28, v17
    v_add_u32 v10, 8, v9
    v_bfe_u32 v11, v10, 3, 2
    v_xor_b32 v10, v10, v11
    v_lshlrev_b32 v18, 4, v10
    v_add_u32 v18, s28, v18
    v_add_u32 v10, 12, v9
    v_bfe_u32 v11, v10, 3, 2
    v_xor_b32 v10, v10, v11
    v_lshlrev_b32 v19, 4, v10
    v_add_u32 v19, s28, v19
    v_add_u32 v10, 16, v9
    v_bfe_u32 v11, v10, 3, 2
    v_xor_b32 v10, v10, v11
    v_lshlrev_b32 v20, 4, v10
    v_add_u32 v20, s28, v20
    v_add_u32 v10, 20, v9
    v_bfe_u32 v11, v10, 3, 2
    v_xor_b32 v10, v10, v11
    v_lshlrev_b32 v21, 4, v10
    v_add_u32 v21, s28, v21
    v_add_u32 v10, 24, v9
    v_bfe_u32 v11, v10, 3, 2
    v_xor_b32 v10, v10, v11
    v_lshlrev_b32 v22, 4, v10
    v_add_u32 v22, s28, v22
    v_add_u32 v10, 28, v9
    v_bfe_u32 v11, v10, 3, 2
    v_xor_b32 v10, v10, v11
    v_lshlrev_b32 v23, 4, v10
    v_add_u32 v23, s28, v23
    s_sub_u32 s31, 3, s23
    s_lshl_b32 s31, s31, 6
    v_subrev_u32 v9, s31, v8
    v_add_u32 v10, 0, v9
    v_bfe_u32 v11, v10, 3, 2
    v_xor_b32 v10, v10, v11
    v_lshlrev_b32 v24, 4, v10
    v_add_u32 v24, s28, v24
    v_add_u32 v10, 4, v9
    v_bfe_u32 v11, v10, 3, 2
    v_xor_b32 v10, v10, v11
    v_lshlrev_b32 v25, 4, v10
    v_add_u32 v25, s28, v25
    v_add_u32 v10, 8, v9
    v_bfe_u32 v11, v10, 3, 2
    v_xor_b32 v10, v10, v11
    v_lshlrev_b32 v26, 4, v10
    v_add_u32 v26, s28, v26
    v_add_u32 v10, 12, v9
    v_bfe_u32 v11, v10, 3, 2
    v_xor_b32 v10, v10, v11
    v_lshlrev_b32 v27, 4, v10
    v_add_u32 v27, s28, v27
    v_add_u32 v10, 16, v9
    v_bfe_u32 v11, v10, 3, 2
    v_xor_b32 v10, v10, v11
    v_lshlrev_b32 v28, 4, v10
    v_add_u32 v28, s28, v28
    v_add_u32 v10, 20, v9
    v_bfe_u32 v11, v10, 3, 2
    v_xor_b32 v10, v10, v11
    v_lshlrev_b32 v29, 4, v10
    v_add_u32 v29, s28, v29
    v_add_u32 v10, 24, v9
    v_bfe_u32 v11, v10, 3, 2
    v_xor_b32 v10, v10, v11
    v_lshlrev_b32 v30, 4, v10
    v_add_u32 v30, s28, v30
    v_add_u32 v10, 28, v9
    v_bfe_u32 v11, v10, 3, 2
    v_xor_b32 v10, v10, v11
    v_lshlrev_b32 v31, 4, v10
    v_add_u32 v31, s28, v31
    v_mov_b32 v64, 0
    v_mov_b32 v65, 0
    v_mov_b32 v66, 0
    v_mov_b32 v67, 0
    v_mov_b32 v68, 0
    v_mov_b32 v69, 0
    v_mov_b32 v70, 0
    v_mov_b32 v71, 0
    v_mov_b32 v72, 0
    v_mov_b32 v73, 0
    v_mov_b32 v74, 0
    v_mov_b32 v75, 0
    v_mov_b32 v76, 0
    v_mov_b32 v77, 0
    v_mov_b32 v78, 0
    v_mov_b32 v79, 0
    s_waitcnt lgkmcnt(0)
    s_barrier
    s_add_u32 s34, s23, 1
K2_C_L1:
    ds_read_b128 v[32:35], v12 offset:0
    ds_read_b128 v[36:39], v12 offset:32
    ds_read_b128 v[40:43], v16 offset:34816
    ds_read_b128 v[44:47], v24 offset:34816
    ds_read_b128 v[96:99], v12 offset:64
    ds_read_b128 v[100:103], v12 offset:96
    ds_read_b128 v[104:107], v17 offset:34816
    ds_read_b128 v[108:111], v25 offset:34816
    s_waitcnt lgkmcnt(4)
    v_mfma_f32_16x16x32_bf16 v[64:67], v[32:35], v[40:43], v[64:67]
    v_mfma_f32_16x16x32_bf16 v[68:71], v[36:39], v[40:43], v[68:71]
    v_mfma_f32_16x16x32_bf16 v[72:75], v[32:35], v[44:47], v[72:75]
    v_mfma_f32_16x16x32_bf16 v[76:79], v[36:39], v[44:47], v[76:79]
    ds_read_b128 v[32:35], v12 offset:128
    ds_read_b128 v[36:39], v12 offset:160
    ds_read_b128 v[40:43], v18 offset:34816
    ds_read_b128 v[44:47], v26 offset:34816
    s_waitcnt lgkmcnt(4)
    v_mfma_f32_16x16x32_bf16 v[64:67], v[96:99], v[104:107], v[64:67]
    v_mfma_f32_16x16x32_bf16 v[68:71], v[100:103], v[104:107], v[68:71]
    v_mfma_f32_16x16x32_bf16 v[72:75], v[96:99], v[108:111], v[72:75]
    v_mfma_f32_16x16x32_bf16 v[76:79], v[100:103], v[108:111], v[76:79]
    ds_read_b128 v[96:99], v12 offset:192
    ds_read_b128 v[100:103], v12 offset:224
    ds_read_b128 v[104:107], v19 offset:34816
    ds_read_b128 v[108:111], v27 offset:34816
    s_waitcnt lgkmcnt(4)
    v_mfma_f32_16x16x32_bf16 v[64:67], v[32:35], v[40:43], v[64:67]
    v_mfma_f32_16x16x32_bf16 v[68:71], v[36:39], v[40:43], v[68:71]
    v_mfma_f32_16x16x32_bf16 v[72:75], v[32:35], v[44:47], v[72:75]
    v_mfma_f32_16x16x32_bf16 v[76:79], v[36:39], v[44:47], v[76:79]
    ds_read_b128 v[32:35], v12 offset:256
    ds_read_b128 v[36:39], v12 offset:288
    ds_read_b128 v[40:43], v20 offset:34816
    ds_read_b128 v[44:47], v28 offset:34816
    s_waitcnt lgkmcnt(4)
    v_mfma_f32_16x16x32_bf16 v[64:67], v[96:99], v[104:107], v[64:67]
    v_mfma_f32_16x16x32_bf16 v[68:71], v[100:103], v[104:107], v[68:71]
    v_mfma_f32_16x16x32_bf16 v[72:75], v[96:99], v[108:111], v[72:75]
    v_mfma_f32_16x16x32_bf16 v[76:79], v[100:103], v[108:111], v[76:79]
    ds_read_b128 v[96:99], v12 offset:320
    ds_read_b128 v[100:103], v12 offset:352
    ds_read_b128 v[104:107], v21 offset:34816
    ds_read_b128 v[108:111], v29 offset:34816
    s_waitcnt lgkmcnt(4)
    v_mfma_f32_16x16x32_bf16 v[64:67], v[32:35], v[40:43], v[64:67]
    v_mfma_f32_16x16x32_bf16 v[68:71], v[36:39], v[40:43], v[68:71]
    v_mfma_f32_16x16x32_bf16 v[72:75], v[32:35], v[44:47], v[72:75]
    v_mfma_f32_16x16x32_bf16 v[76:79], v[36:39], v[44:47], v[76:79]
    ds_read_b128 v[32:35], v12 offset:384
    ds_read_b128 v[36:39], v12 offset:416
    ds_read_b128 v[40:43], v22 offset:34816
    ds_read_b128 v[44:47], v30 offset:34816
    s_waitcnt lgkmcnt(4)
    v_mfma_f32_16x16x32_bf16 v[64:67], v[96:99], v[104:107], v[64:67]
    v_mfma_f32_16x16x32_bf16 v[68:71], v[100:103], v[104:107], v[68:71]
    v_mfma_f32_16x16x32_bf16 v[72:75], v[96:99], v[108:111], v[72:75]
    v_mfma_f32_16x16x32_bf16 v[76:79], v[100:103], v[108:111], v[76:79]
    ds_read_b128 v[96:99], v12 offset:448
    ds_read_b128 v[100:103], v12 offset:480
    ds_read_b128 v[104:107], v23 offset:34816
    ds_read_b128 v[108:111], v31 offset:34816
    s_waitcnt lgkmcnt(4)
    v_mfma_f32_16x16x32_bf16 v[64:67], v[32:35], v[40:43], v[64:67]
    v_mfma_f32_16x16x32_bf16 v[68:71], v[36:39], v[40:43], v[68:71]
    v_mfma_f32_16x16x32_bf16 v[72:75], v[32:35], v[44:47], v[72:75]
    v_mfma_f32_16x16x32_bf16 v[76:79], v[36:39], v[44:47], v[76:79]
    ds_read_b128 v[32:35], v12 offset:512
    ds_read_b128 v[36:39], v12 offset:544
    ds_read_b128 v[40:43], v16 offset:35328
    ds_read_b128 v[44:47], v24 offset:35328
    s_waitcnt lgkmcnt(4)
    v_mfma_f32_16x16x32_bf16 v[64:67], v[96:99], v[104:107], v[64:67]
    v_mfma_f32_16x16x32_bf16 v[68:71], v[100:103], v[104:107], v[68:71]
    v_mfma_f32_16x16x32_bf16 v[72:75], v[96:99], v[108:111], v[72:75]
    v_mfma_f32_16x16x32_bf16 v[76:79], v[100:103], v[108:111], v[76:79]
    ds_read_b128 v[96:99], v12 offset:576
    ds_read_b128 v[100:103], v12 offset:608
    ds_read_b128 v[104:107], v17 offset:35328
    ds_read_b128 v[108:111], v25 offset:35328
    s_waitcnt lgkmcnt(4)
    v_mfma_f32_16x16x32_bf16 v[64:67], v[32:35], v[40:43], v[64:67]
    v_mfma_f32_16x16x32_bf16 v[68:71], v[36:39], v[40:43], v[68:71]
    v_mfma_f32_16x16x32_bf16 v[72:75], v[32:35], v[44:47], v[72:75]
    v_mfma_f32_16x16x32_bf16 v[76:79], v[36:39], v[44:47], v[76:79]
    ds_read_b128 v[32:35], v12 offset:640
    ds_read_b128 v[36:39], v12 offset:672
    ds_read_b128 v[40:43], v18 offset:35328
    ds_read_b128 v[44:47], v26 offset:35328
    s_waitcnt lgkmcnt(4)
    v_mfma_f32_16x16x32_bf16 v[64:67], v[96:99], v[104:107], v[64:67]
    v_mfma_f32_16x16x32_bf16 v[68:71], v[100:103], v[104:107], v[68:71]
    v_mfma_f32_16x16x32_bf16 v[72:75], v[96:99], v[108:111], v[72:75]
    v_mfma_f32_16x16x32_bf16 v[76:79], v[100:103], v[108:111], v[76:79]
    ds_read_b128 v[96:99], v12 offset:704
    ds_read_b128 v[100:103], v12 offset:736
    ds_read_b128 v[104:107], v19 offset:35328
    ds_read_b128 v[108:111], v27 offset:35328
    s_waitcnt lgkmcnt(4)
    v_mfma_f32_16x16x32_bf16 v[64:67], v[32:35], v[40:43], v[64:67]
    v_mfma_f32_16x16x32_bf16 v[68:71], v[36:39], v[40:43], v[68:71]
    v_mfma_f32_16x16x32_bf16 v[72:75], v[32:35], v[44:47], v[72:75]
    v_mfma_f32_16x16x32_bf16 v[76:79], v[36:39], v[44:47], v[76:79]
    ds_read_b128 v[32:35], v12 offset:768
    ds_read_b128 v[36:39], v12 offset:800
    ds_read_b128 v[40:43], v20 offset:35328
    ds_read_b128 v[44:47], v28 offset:35328
    s_waitcnt lgkmcnt(4)
    v_mfma_f32_16x16x32_bf16 v[64:67], v[96:99], v[104:107], v[64:67]
    v_mfma_f32_16x16x32_bf16 v[68:71], v[100:103], v[104:107], v[68:71]
    v_mfma_f32_16x16x32_bf16 v[72:75], v[96:99], v[108:111], v[72:75]
    v_mfma_f32_16x16x32_bf16 v[76:79], v[100:103], v[108:111], v[76:79]
    ds_read_b128 v[96:99], v12 offset:832
    ds_read_b128 v[100:103], v12 offset:864
    ds_read_b128 v[104:107], v21 offset:35328
    ds_read_b128 v[108:111], v29 offset:35328
    s_waitcnt lgkmcnt(4)
    v_mfma_f32_16x16x32_bf16 v[64:67], v[32:35], v[40:43], v[64:67]
    v_mfma_f32_16x16x32_bf16 v[68:71], v[36:39], v[40:43], v[68:71]
    v_mfma_f32_16x16x32_bf16 v[72:75], v[32:35], v[44:47], v[72:75]
    v_mfma_f32_16x16x32_bf16 v[76:79], v[36:39], v[44:47], v[76:79]
    ds_read_b128 v[32:35], v12 offset:896
    ds_read_b128 v[36:39], v12 offset:928
    ds_read_b128 v[40:43], v22 offset:35328
    ds_read_b128 v[44:47], v30 offset:35328
    s_waitcnt lgkmcnt(4)
    v_mfma_f32_16x16x32_bf16 v[64:67], v[96:99], v[104:107], v[64:67]
    v_mfma_f32_16x16x32_bf16 v[68:71], v[100:103], v[104:107], v[68:71]
    v_mfma_f32_16x16x32_bf16 v[72:75], v[96:99], v[108:111], v[72:75]
    v_mfma_f32_16x16x32_bf16 v[76:79], v[100:103], v[108:111], v[76:79]
    ds_read_b128 v[96:99], v12 offset:960
    ds_read_b128 v[100:103], v12 offset:992
    ds_read_b128 v[104:107], v23 offset:35328
    ds_read_b128 v[108:111], v31 offset:35328
    s_waitcnt lgkmcnt(4)
    v_mfma_f32_16x16x32_bf16 v[64:67], v[32:35], v[40:43], v[64:67]
    v_mfma_f32_16x16x32_bf16 v[68:71], v[36:39], v[40:43], v[68:71]
    v_mfma_f32_16x16x32_bf16 v[72:75], v[32:35], v[44:47], v[72:75]
    v_mfma_f32_16x16x32_bf16 v[76:79], v[36:39], v[44:47], v[76:79]
    s_waitcnt lgkmcnt(0)
    v_mfma_f32_16x16x32_bf16 v[64:67], v[96:99], v[104:107], v[64:67]
    v_mfma_f32_16x16x32_bf16 v[68:71], v[100:103], v[104:107], v[68:71]
    v_mfma_f32_16x16x32_bf16 v[72:75], v[96:99], v[108:111], v[72:75]
    v_mfma_f32_16x16x32_bf16 v[76:79], v[100:103], v[108:111], v[76:79]
    v_add_u32 v12, 1024, v12
    v_add_u32 v16, 1024, v16
    v_add_u32 v17, 1024, v17
    v_add_u32 v18, 1024, v18
    v_add_u32 v19, 1024, v19
    v_add_u32 v20, 1024, v20
    v_add_u32 v21, 1024, v21
    v_add_u32 v22, 1024, v22
    v_add_u32 v23, 1024, v23
    v_add_u32 v24, 1024, v24
    v_add_u32 v25, 1024, v25
    v_add_u32 v26, 1024, v26
    v_add_u32 v27, 1024, v27
    v_add_u32 v28, 1024, v28
    v_add_u32 v29, 1024, v29
    v_add_u32 v30, 1024, v30
    v_add_u32 v31, 1024, v31
    s_sub_u32 s34, s34, 1
    s_cmp_gt_u32 s34, 0
    s_cbranch_scc1 K2_C_L1
    s_lshl_b32 s34, s23, 1
    s_sub_u32 s34, 3, s34
K2_C_L2:
    ds_read_b128 v[32:35], v12 offset:0
    ds_read_b128 v[36:39], v12 offset:32
    ds_read_b128 v[44:47], v24 offset:34816
    ds_read_b128 v[96:99], v12 offset:64
    ds_read_b128 v[100:103], v12 offset:96
    ds_read_b128 v[108:111], v25 offset:34816
    s_waitcnt lgkmcnt(3)
    v_mfma_f32_16x16x32_bf16 v[72:75], v[32:35], v[44:47], v[72:75]
    v_mfma_f32_16x16x32_bf16 v[76:79], v[36:39], v[44:47], v[76:79]
    ds_read_b128 v[32:35], v12 offset:128
    ds_read_b128 v[36:39], v12 offset:160
    ds_read_b128 v[44:47], v26 offset:34816
    s_waitcnt lgkmcnt(3)
    v_mfma_f32_16x16x32_bf16 v[72:75], v[96:99], v[108:111], v[72:75]
    v_mfma_f32_16x16x32_bf16 v[76:79], v[100:103], v[108:111], v[76:79]
    ds_read_b128 v[96:99], v12 offset:192
    ds_read_b128 v[100:103], v12 offset:224
    ds_read_b128 v[108:111], v27 offset:34816
    s_waitcnt lgkmcnt(3)
    v_mfma_f32_16x16x32_bf16 v[72:75], v[32:35], v[44:47], v[72:75]
    v_mfma_f32_16x16x32_bf16 v[76:79], v[36:39], v[44:47], v[76:79]
    ds_read_b128 v[32:35], v12 offset:256
    ds_read_b128 v[36:39], v12 offset:288
    ds_read_b128 v[44:47], v28 offset:34816
    s_waitcnt lgkmcnt(3)
    v_mfma_f32_16x16x32_bf16 v[72:75], v[96:99], v[108:111], v[72:75]
    v_mfma_f32_16x16x32_bf16 v[76:79], v[100:103], v[108:111], v[76:79]
    ds_read_b128 v[96:99], v12 offset:320
    ds_read_b128 v[100:103], v12 offset:352
    ds_read_b128 v[108:111], v29 offset:34816
    s_waitcnt lgkmcnt(3)
    v_mfma_f32_16x16x32_bf16 v[72:75], v[32:35], v[44:47], v[72:75]
    v_mfma_f32_16x16x32_bf16 v[76:79], v[36:39], v[44:47], v[76:79]
    ds_read_b128 v[32:35], v12 offset:384
    ds_read_b128 v[36:39], v12 offset:416
    ds_read_b128 v[44:47], v30 offset:34816
    s_waitcnt lgkmcnt(3)
    v_mfma_f32_16x16x32_bf16 v[72:75], v[96:99], v[108:111], v[72:75]
    v_mfma_f32_16x16x32_bf16 v[76:79], v[100:103], v[108:111], v[76:79]
    ds_read_b128 v[96:99], v12 offset:448
    ds_read_b128 v[100:103], v12 offset:480
    ds_read_b128 v[108:111], v31 offset:34816
    s_waitcnt lgkmcnt(3)
    v_mfma_f32_16x16x32_bf16 v[72:75], v[32:35], v[44:47], v[72:75]
    v_mfma_f32_16x16x32_bf16 v[76:79], v[36:39], v[44:47], v[76:79]
    ds_read_b128 v[32:35], v12 offset:512
    ds_read_b128 v[36:39], v12 offset:544
    ds_read_b128 v[44:47], v24 offset:35328
    s_waitcnt lgkmcnt(3)
    v_mfma_f32_16x16x32_bf16 v[72:75], v[96:99], v[108:111], v[72:75]
    v_mfma_f32_16x16x32_bf16 v[76:79], v[100:103], v[108:111], v[76:79]
    ds_read_b128 v[96:99], v12 offset:576
    ds_read_b128 v[100:103], v12 offset:608
    ds_read_b128 v[108:111], v25 offset:35328
    s_waitcnt lgkmcnt(3)
    v_mfma_f32_16x16x32_bf16 v[72:75], v[32:35], v[44:47], v[72:75]
    v_mfma_f32_16x16x32_bf16 v[76:79], v[36:39], v[44:47], v[76:79]
    ds_read_b128 v[32:35], v12 offset:640
    ds_read_b128 v[36:39], v12 offset:672
    ds_read_b128 v[44:47], v26 offset:35328
    s_waitcnt lgkmcnt(3)
    v_mfma_f32_16x16x32_bf16 v[72:75], v[96:99], v[108:111], v[72:75]
    v_mfma_f32_16x16x32_bf16 v[76:79], v[100:103], v[108:111], v[76:79]
    ds_read_b128 v[96:99], v12 offset:704
    ds_read_b128 v[100:103], v12 offset:736
    ds_read_b128 v[108:111], v27 offset:35328
    s_waitcnt lgkmcnt(3)
    v_mfma_f32_16x16x32_bf16 v[72:75], v[32:35], v[44:47], v[72:75]
    v_mfma_f32_16x16x32_bf16 v[76:79], v[36:39], v[44:47], v[76:79]
    ds_read_b128 v[32:35], v12 offset:768
    ds_read_b128 v[36:39], v12 offset:800
    ds_read_b128 v[44:47], v28 offset:35328
    s_waitcnt lgkmcnt(3)
    v_mfma_f32_16x16x32_bf16 v[72:75], v[96:99], v[108:111], v[72:75]
    v_mfma_f32_16x16x32_bf16 v[76:79], v[100:103], v[108:111], v[76:79]
    ds_read_b128 v[96:99], v12 offset:832
    ds_read_b128 v[100:103], v12 offset:864
    ds_read_b128 v[108:111], v29 offset:35328
    s_waitcnt lgkmcnt(3)
    v_mfma_f32_16x16x32_bf16 v[72:75], v[32:35], v[44:47], v[72:75]
    v_mfma_f32_16x16x32_bf16 v[76:79], v[36:39], v[44:47], v[76:79]
    ds_read_b128 v[32:35], v12 offset:896
    ds_read_b128 v[36:39], v12 offset:928
    ds_read_b128 v[44:47], v30 offset:35328
    s_waitcnt lgkmcnt(3)
    v_mfma_f32_16x16x32_bf16 v[72:75], v[96:99], v[108:111], v[72:75]
    v_mfma_f32_16x16x32_bf16 v[76:79], v[100:103], v[108:111], v[76:79]
    ds_read_b128 v[96:99], v12 offset:960
    ds_read_b128 v[100:103], v12 offset:992
    ds_read_b128 v[108:111], v31 offset:35328
    s_waitcnt lgkmcnt(3)
    v_mfma_f32_16x16x32_bf16 v[72:75], v[32:35], v[44:47], v[72:75]
    v_mfma_f32_16x16x32_bf16 v[76:79], v[36:39], v[44:47], v[76:79]
    s_waitcnt lgkmcnt(0)
    v_mfma_f32_16x16x32_bf16 v[72:75], v[96:99], v[108:111], v[72:75]
    v_mfma_f32_16x16x32_bf16 v[76:79], v[100:103], v[108:111], v[76:79]
    v_add_u32 v12, 1024, v12
    v_add_u32 v16, 1024, v16
    v_add_u32 v17, 1024, v17
    v_add_u32 v18, 1024, v18
    v_add_u32 v19, 1024, v19
    v_add_u32 v20, 1024, v20
    v_add_u32 v21, 1024, v21
    v_add_u32 v22, 1024, v22
    v_add_u32 v23, 1024, v23
    v_add_u32 v24, 1024, v24
    v_add_u32 v25, 1024, v25
    v_add_u32 v26, 1024, v26
    v_add_u32 v27, 1024, v27
    v_add_u32 v28, 1024, v28
    v_add_u32 v29, 1024, v29
    v_add_u32 v30, 1024, v30
    v_add_u32 v31, 1024, v31
    s_sub_u32 s34, s34, 1
    s_cmp_gt_u32 s34, 0
    s_cbranch_scc1 K2_C_L2
    v_lshlrev_b32 v154, 16, v154
    v_and_b32 v8, 15, v63
    v_lshrrev_b32 v10, 4, v63
    s_nop 7
    s_lshl_b32 s31, s23, 9
    v_lshlrev_b32 v9, 5, v8
    v_lshl_add_u32 v9, v10, 2, v9
    v_add_u32 v9, s31, v9
    v_sub_u32 v11, 2044, v9
    v_lshrrev_b32 v13, 3, v11
    v_bfe_u32 v14, v13, 3, 2
    v_xor_b32 v13, v13, v14
    v_lshlrev_b32 v13, 4, v13
    v_and_b32 v14, 4, v11
    v_lshl_add_u32 v13, v14, 1, v13
    v_add_u32 v13, s28, v13
    ds_read_b64 v[14:15], v13 offset:34816
    s_waitcnt lgkmcnt(0)
    v_lshlrev_b32 v83, 16, v14
    v_and_b32 v82, 0xffff0000, v14
    v_lshlrev_b32 v81, 16, v15
    v_and_b32 v80, 0xffff0000, v15
    v_mul_f32 v80, v80, v154
    v_cvt_pk_bf16_f32 v80, v80, v80
    v_lshlrev_b32 v80, 16, v80
    v_cvt_pk_bf16_f32 v84, v64, v64
    v_lshlrev_b32 v84, 16, v84
    v_add_f32 v80, v80, v84
    v_mul_f32 v81, v81, v154
    v_cvt_pk_bf16_f32 v81, v81, v81
    v_lshlrev_b32 v81, 16, v81
    v_cvt_pk_bf16_f32 v84, v65, v65
    v_lshlrev_b32 v84, 16, v84
    v_add_f32 v81, v81, v84
    v_mul_f32 v82, v82, v154
    v_cvt_pk_bf16_f32 v82, v82, v82
    v_lshlrev_b32 v82, 16, v82
    v_cvt_pk_bf16_f32 v84, v66, v66
    v_lshlrev_b32 v84, 16, v84
    v_add_f32 v82, v82, v84
    v_mul_f32 v83, v83, v154
    v_cvt_pk_bf16_f32 v83, v83, v83
    v_lshlrev_b32 v83, 16, v83
    v_cvt_pk_bf16_f32 v84, v67, v67
    v_lshlrev_b32 v84, 16, v84
    v_add_f32 v83, v83, v84
    v_cvt_pk_bf16_f32 v86, v80, v81
    v_cvt_pk_bf16_f32 v87, v82, v83
    v_lshlrev_b32 v9, 1, v9
    buffer_store_dwordx2 v[86:87], v9, s[16:19], 0 offen
    s_nop 1
    s_lshl_b32 s31, s23, 9
    v_lshlrev_b32 v9, 5, v8
    v_lshl_add_u32 v9, v10, 2, v9
    v_add_u32 v9, s31, v9
    v_add_u32 v9, 16, v9
    v_sub_u32 v11, 2044, v9
    v_lshrrev_b32 v13, 3, v11
    v_bfe_u32 v14, v13, 3, 2
    v_xor_b32 v13, v13, v14
    v_lshlrev_b32 v13, 4, v13
    v_and_b32 v14, 4, v11
    v_lshl_add_u32 v13, v14, 1, v13
    v_add_u32 v13, s28, v13
    ds_read_b64 v[14:15], v13 offset:34816
    s_waitcnt lgkmcnt(0)
    v_lshlrev_b32 v83, 16, v14
    v_and_b32 v82, 0xffff0000, v14
    v_lshlrev_b32 v81, 16, v15
    v_and_b32 v80, 0xffff0000, v15
    v_mul_f32 v80, v80, v154
    v_cvt_pk_bf16_f32 v80, v80, v80
    v_lshlrev_b32 v80, 16, v80
    v_cvt_pk_bf16_f32 v84, v68, v68
    v_lshlrev_b32 v84, 16, v84
    v_add_f32 v80, v80, v84
    v_mul_f32 v81, v81, v154
    v_cvt_pk_bf16_f32 v81, v81, v81
    v_lshlrev_b32 v81, 16, v81
    v_cvt_pk_bf16_f32 v84, v69, v69
    v_lshlrev_b32 v84, 16, v84
    v_add_f32 v81, v81, v84
    v_mul_f32 v82, v82, v154
    v_cvt_pk_bf16_f32 v82, v82, v82
    v_lshlrev_b32 v82, 16, v82
    v_cvt_pk_bf16_f32 v84, v70, v70
    v_lshlrev_b32 v84, 16, v84
    v_add_f32 v82, v82, v84
    v_mul_f32 v83, v83, v154
    v_cvt_pk_bf16_f32 v83, v83, v83
    v_lshlrev_b32 v83, 16, v83
    v_cvt_pk_bf16_f32 v84, v71, v71
    v_lshlrev_b32 v84, 16, v84
    v_add_f32 v83, v83, v84
    v_cvt_pk_bf16_f32 v86, v80, v81
    v_cvt_pk_bf16_f32 v87, v82, v83
    v_lshlrev_b32 v9, 1, v9
    buffer_store_dwordx2 v[86:87], v9, s[16:19], 0 offen
    s_nop 1
    s_sub_u32 s31, 3, s23
    s_lshl_b32 s31, s31, 9
    v_lshlrev_b32 v9, 5, v8
    v_lshl_add_u32 v9, v10, 2, v9
    v_add_u32 v9, s31, v9
    v_sub_u32 v11, 2044, v9
    v_lshrrev_b32 v13, 3, v11
    v_bfe_u32 v14, v13, 3, 2
    v_xor_b32 v13, v13, v14
    v_lshlrev_b32 v13, 4, v13
    v_and_b32 v14, 4, v11
    v_lshl_add_u32 v13, v14, 1, v13
    v_add_u32 v13, s28, v13
    ds_read_b64 v[14:15], v13 offset:34816
    s_waitcnt lgkmcnt(0)
    v_lshlrev_b32 v83, 16, v14
    v_and_b32 v82, 0xffff0000, v14
    v_lshlrev_b32 v81, 16, v15
    v_and_b32 v80, 0xffff0000, v15
    v_mul_f32 v80, v80, v154
    v_cvt_pk_bf16_f32 v80, v80, v80
    v_lshlrev_b32 v80, 16, v80
    v_cvt_pk_bf16_f32 v84, v72, v72
    v_lshlrev_b32 v84, 16, v84
    v_add_f32 v80, v80, v84
    v_mul_f32 v81, v81, v154
    v_cvt_pk_bf16_f32 v81, v81, v81
    v_lshlrev_b32 v81, 16, v81
    v_cvt_pk_bf16_f32 v84, v73, v73
    v_lshlrev_b32 v84, 16, v84
    v_add_f32 v81, v81, v84
    v_mul_f32 v82, v82, v154
    v_cvt_pk_bf16_f32 v82, v82, v82
    v_lshlrev_b32 v82, 16, v82
    v_cvt_pk_bf16_f32 v84, v74, v74
    v_lshlrev_b32 v84, 16, v84
    v_add_f32 v82, v82, v84
    v_mul_f32 v83, v83, v154
    v_cvt_pk_bf16_f32 v83, v83, v83
    v_lshlrev_b32 v83, 16, v83
    v_cvt_pk_bf16_f32 v84, v75, v75
    v_lshlrev_b32 v84, 16, v84
    v_add_f32 v83, v83, v84
    v_cvt_pk_bf16_f32 v86, v80, v81
    v_cvt_pk_bf16_f32 v87, v82, v83
    v_lshlrev_b32 v9, 1, v9
    buffer_store_dwordx2 v[86:87], v9, s[16:19], 0 offen
    s_nop 1
    s_sub_u32 s31, 3, s23
    s_lshl_b32 s31, s31, 9
    v_lshlrev_b32 v9, 5, v8
    v_lshl_add_u32 v9, v10, 2, v9
    v_add_u32 v9, s31, v9
    v_add_u32 v9, 16, v9
    v_sub_u32 v11, 2044, v9
    v_lshrrev_b32 v13, 3, v11
    v_bfe_u32 v14, v13, 3, 2
    v_xor_b32 v13, v13, v14
    v_lshlrev_b32 v13, 4, v13
    v_and_b32 v14, 4, v11
    v_lshl_add_u32 v13, v14, 1, v13
    v_add_u32 v13, s28, v13
    ds_read_b64 v[14:15], v13 offset:34816
    s_waitcnt lgkmcnt(0)
    v_lshlrev_b32 v83, 16, v14
    v_and_b32 v82, 0xffff0000, v14
    v_lshlrev_b32 v81, 16, v15
    v_and_b32 v80, 0xffff0000, v15
    v_mul_f32 v80, v80, v154
    v_cvt_pk_bf16_f32 v80, v80, v80
    v_lshlrev_b32 v80, 16, v80
    v_cvt_pk_bf16_f32 v84, v76, v76
    v_lshlrev_b32 v84, 16, v84
    v_add_f32 v80, v80, v84
    v_mul_f32 v81, v81, v154
    v_cvt_pk_bf16_f32 v81, v81, v81
    v_lshlrev_b32 v81, 16, v81
    v_cvt_pk_bf16_f32 v84, v77, v77
    v_lshlrev_b32 v84, 16, v84
    v_add_f32 v81, v81, v84
    v_mul_f32 v82, v82, v154
    v_cvt_pk_bf16_f32 v82, v82, v82
    v_lshlrev_b32 v82, 16, v82
    v_cvt_pk_bf16_f32 v84, v78, v78
    v_lshlrev_b32 v84, 16, v84
    v_add_f32 v82, v82, v84
    v_mul_f32 v83, v83, v154
    v_cvt_pk_bf16_f32 v83, v83, v83
    v_lshlrev_b32 v83, 16, v83
    v_cvt_pk_bf16_f32 v84, v79, v79
    v_lshlrev_b32 v84, 16, v84
    v_add_f32 v83, v83, v84
    v_cvt_pk_bf16_f32 v86, v80, v81
    v_cvt_pk_bf16_f32 v87, v82, v83
    v_lshlrev_b32 v9, 1, v9
    buffer_store_dwordx2 v[86:87], v9, s[16:19], 0 offen
    s_nop 1
    s_endpgm
K2_GEMM:
    s_add_u32 s36, s4, 0
    s_addc_u32 s37, s5, 0
    s_mov_b32 s38, 2097152
    s_mov_b32 s39, 0x00020000
    s_add_u32 s16, s4, 6389760
    s_addc_u32 s17, s5, 0
    s_mov_b32 s18, 5636096
    s_mov_b32 s19, 0x00020000
    s_and_b32 s22, s2, 7
    s_mul_i32 s22, s22, 31
    s_lshr_b32 s23, s2, 3
    s_add_u32 s22, s22, s23
    s_cmp_ge_u32 s22, 242
    s_cbranch_scc1 K2_END
    s_cmp_ge_u32 s22, 132
    s_cbranch_scc1 K2_G_M5
    s_cmp_ge_u32 s22, 66
    s_cselect_b32 s23, 66, 0
    s_cselect_b32 s24, 6, 0
    s_sub_u32 s23, s22, s23
    s_mul_i32 s21, s23, 43691
    s_lshr_b32 s21, s21, 18
    s_mul_i32 s20, s21, 6
    s_sub_u32 s20, s23, s20
    s_add_u32 s20, s20, s24
    s_branch K2_G_MD
K2_G_M5:
    s_sub_u32 s22, s22, 132
    s_cmp_ge_u32 s22, 55
    s_cselect_b32 s23, 55, 0
    s_cselect_b32 s24, 17, 12
    s_sub_u32 s23, s22, s23
    s_mul_i32 s21, s23, 52429
    s_lshr_b32 s21, s21, 18
    s_mul_i32 s20, s21, 5
    s_sub_u32 s20, s23, s20
    s_add_u32 s20, s20, s24
K2_G_MD:
    s_lshr_b32 s22, s30, 1
    s_and_b32 s23, s30, 1
    s_waitcnt lgkmcnt(0)
    s_add_u32 s8, s4, 2097152
    s_addc_u32 s9, s5, 0
    s_mov_b32 s10, 2883584
    s_mov_b32 s11, 0x00020000
    v_lshlrev_b32 v2, 4, v63
    s_lshl_b32 s24, s20, 2
    s_add_u32 s24, s24, s30
    s_lshl_b32 s24, s24, 14
    s_add_u32 s44, s24, 1441792
    s_mul_i32 s25, s21, 12
    s_mul_i32 s26, s30, 3
    s_add_u32 s25, s25, s26
    s_lshl_b32 s25, s25, 14
    s_add_u32 s26, s25, 16384
    s_add_u32 s27, s25, 32768
    s_lshl_b32 s28, s30, 10
    s_mul_i32 s29, s30, 3072
    s_add_u32 s29, s29, 8192
    s_add_u32 m0, s28, 0
    s_nop 0
    buffer_load_dwordx4 v2, s[8:11], s24 offen lds
    s_add_u32 m0, s28, 4096
    s_nop 0
    buffer_load_dwordx4 v2, s[8:11], s44 offen lds
    s_add_u32 m0, s29, 0
    s_nop 0
    buffer_load_dwordx4 v2, s[36:39], s25 offen lds
    s_add_u32 m0, s29, 1024
    s_nop 0
    buffer_load_dwordx4 v2, s[36:39], s26 offen lds
    s_add_u32 m0, s29, 2048
    s_nop 0
    buffer_load_dwordx4 v2, s[36:39], s27 offen lds
    s_add_u32 s24, s24, 1024
    s_add_u32 s44, s44, 1024
    s_add_u32 s25, s25, 1024
    s_add_u32 s26, s26, 1024
    s_add_u32 s27, s27, 1024
    s_add_u32 m0, s28, 20480
    s_nop 0
    buffer_load_dwordx4 v2, s[8:11], s24 offen lds
    s_add_u32 m0, s28, 24576
    s_nop 0
    buffer_load_dwordx4 v2, s[8:11], s44 offen lds
    s_add_u32 m0, s29, 20480
    s_nop 0
    buffer_load_dwordx4 v2, s[36:39], s25 offen lds
    s_add_u32 m0, s29, 21504
    s_nop 0
    buffer_load_dwordx4 v2, s[36:39], s26 offen lds
    s_add_u32 m0, s29, 22528
    s_nop 0
    buffer_load_dwordx4 v2, s[36:39], s27 offen lds
    s_add_u32 s24, s24, 1024
    s_add_u32 s44, s44, 1024
    s_add_u32 s25, s25, 1024
    s_add_u32 s26, s26, 1024
    s_add_u32 s27, s27, 1024
    s_add_u32 m0, s28, 40960
    s_nop 0
    buffer_load_dwordx4 v2, s[8:11], s24 offen lds
    s_add_u32 m0, s28, 45056
    s_nop 0
    buffer_load_dwordx4 v2, s[8:11], s44 offen lds
    s_add_u32 m0, s29, 40960
    s_nop 0
    buffer_load_dwordx4 v2, s[36:39], s25 offen lds
    s_add_u32 m0, s29, 41984
    s_nop 0
    buffer_load_dwordx4 v2, s[36:39], s26 offen lds
    s_add_u32 m0, s29, 43008
    s_nop 0
    buffer_load_dwordx4 v2, s[36:39], s27 offen lds
    s_add_u32 s24, s24, 1024
    s_add_u32 s44, s44, 1024
    s_add_u32 s25, s25, 1024
    s_add_u32 s26, s26, 1024
    s_add_u32 s27, s27, 1024
    s_lshl_b32 s31, s23, 11
    v_add_u32 v3, s31, v2
    s_mul_i32 s31, s22, 6144
    s_add_u32 s31, s31, 8192
    v_add_u32 v5, s31, v2
    v_add_u32 v6, 61440, v3
    v_add_u32 v8, 61440, v5
    v_mov_b32 v64, 0
    v_mov_b32 v65, 0
    v_mov_b32 v66, 0
    v_mov_b32 v67, 0
    v_mov_b32 v68, 0
    v_mov_b32 v69, 0
    v_mov_b32 v70, 0
    v_mov_b32 v71, 0
    v_mov_b32 v72, 0
    v_mov_b32 v73, 0
    v_mov_b32 v74, 0
    v_mov_b32 v75, 0
    v_mov_b32 v76, 0
    v_mov_b32 v77, 0
    v_mov_b32 v78, 0
    v_mov_b32 v79, 0
    v_mov_b32 v80, 0
    v_mov_b32 v81, 0
    v_mov_b32 v82, 0
    v_mov_b32 v83, 0
    v_mov_b32 v84, 0
    v_mov_b32 v85, 0
    v_mov_b32 v86, 0
    v_mov_b32 v87, 0
    v_mov_b32 v88, 0
    v_mov_b32 v89, 0
    v_mov_b32 v90, 0
    v_mov_b32 v91, 0
    v_mov_b32 v92, 0
    v_mov_b32 v93, 0
    v_mov_b32 v94, 0
    v_mov_b32 v95, 0
    v_mov_b32 v96, 0
    v_mov_b32 v97, 0
    v_mov_b32 v98, 0
    v_mov_b32 v99, 0
    v_mov_b32 v100, 0
    v_mov_b32 v101, 0
    v_mov_b32 v102, 0
    v_mov_b32 v103, 0
    v_mov_b32 v104, 0
    v_mov_b32 v105, 0
    v_mov_b32 v106, 0
    v_mov_b32 v107, 0
    v_mov_b32 v108, 0
    v_mov_b32 v109, 0
    v_mov_b32 v110, 0
    v_mov_b32 v111, 0
    v_mov_b32 v112, 0
    v_mov_b32 v113, 0
    v_mov_b32 v114, 0
    v_mov_b32 v115, 0
    v_mov_b32 v116, 0
    v_mov_b32 v117, 0
    v_mov_b32 v118, 0
    v_mov_b32 v119, 0
    v_mov_b32 v120, 0
    v_mov_b32 v121, 0
    v_mov_b32 v122, 0
    v_mov_b32 v123, 0
    v_mov_b32 v124, 0
    v_mov_b32 v125, 0
    v_mov_b32 v126, 0
    v_mov_b32 v127, 0
    v_mov_b32 v128, 0
    v_mov_b32 v129, 0
    v_mov_b32 v130, 0
    v_mov_b32 v131, 0
    v_mov_b32 v132, 0
    v_mov_b32 v133, 0
    v_mov_b32 v134, 0
    v_mov_b32 v135, 0
    v_mov_b32 v136, 0
    v_mov_b32 v137, 0
    v_mov_b32 v138, 0
    v_mov_b32 v139, 0
    v_mov_b32 v140, 0
    v_mov_b32 v141, 0
    v_mov_b32 v142, 0
    v_mov_b32 v143, 0
    v_mov_b32 v144, 0
    v_mov_b32 v145, 0
    v_mov_b32 v146, 0
    v_mov_b32 v147, 0
    v_mov_b32 v148, 0
    v_mov_b32 v149, 0
    v_mov_b32 v150, 0
    v_mov_b32 v151, 0
    v_mov_b32 v152, 0
    v_mov_b32 v153, 0
    v_mov_b32 v154, 0
    v_mov_b32 v155, 0
    v_mov_b32 v156, 0
    v_mov_b32 v157, 0
    v_mov_b32 v158, 0
    v_mov_b32 v159, 0
    s_waitcnt vmcnt(10)
    s_barrier
    ds_read_b128 v[160:163], v3 offset:0
    ds_read_b128 v[164:167], v3 offset:1024
    ds_read_b128 v[168:171], v3 offset:4096
    ds_read_b128 v[172:175], v3 offset:5120
    ds_read_b128 v[176:179], v5 offset:0
    ds_read_b128 v[180:183], v5 offset:1024
    ds_read_b128 v[184:187], v5 offset:2048
    ds_read_b128 v[188:191], v5 offset:3072
    ds_read_b128 v[192:195], v5 offset:4096
    ds_read_b128 v[196:199], v5 offset:5120
    s_waitcnt vmcnt(5)
    s_barrier
    s_waitcnt lgkmcnt(0)
    v_mfma_f32_16x16x32_bf16 v[64:67], v[160:163], v[176:179], v[64:67]
    v_mfma_f32_16x16x32_bf16 v[88:91], v[164:167], v[176:179], v[88:91]
    ds_read_b128 v[200:203], v3 offset:20480
    v_mfma_f32_16x16x32_bf16 v[112:115], v[168:171], v[176:179], v[112:115]
    ds_read_b128 v[204:207], v3 offset:21504
    v_mfma_f32_16x16x32_bf16 v[136:139], v[172:175], v[176:179], v[136:139]
    s_add_u32 m0, s28, 61440
    s_nop 0
    buffer_load_dwordx4 v2, s[8:11], s24 offen lds
    v_mfma_f32_16x16x32_bf16 v[68:71], v[160:163], v[180:183], v[68:71]
    ds_read_b128 v[208:211], v3 offset:24576
    v_mfma_f32_16x16x32_bf16 v[92:95], v[164:167], v[180:183], v[92:95]
    ds_read_b128 v[212:215], v3 offset:25600
    v_mfma_f32_16x16x32_bf16 v[116:119], v[168:171], v[180:183], v[116:119]
    s_add_u32 m0, s28, 65536
    s_nop 0
    buffer_load_dwordx4 v2, s[8:11], s44 offen lds
    v_mfma_f32_16x16x32_bf16 v[140:143], v[172:175], v[180:183], v[140:143]
    ds_read_b128 v[216:219], v5 offset:20480
    v_mfma_f32_16x16x32_bf16 v[72:75], v[160:163], v[184:187], v[72:75]
    ds_read_b128 v[220:223], v5 offset:21504
    v_mfma_f32_16x16x32_bf16 v[96:99], v[164:167], v[184:187], v[96:99]
    s_add_u32 m0, s29, 61440
    s_nop 0
    buffer_load_dwordx4 v2, s[36:39], s25 offen lds
    v_mfma_f32_16x16x32_bf16 v[120:123], v[168:171], v[184:187], v[120:123]
    ds_read_b128 v[224:227], v5 offset:22528
    v_mfma_f32_16x16x32_bf16 v[144:147], v[172:175], v[184:187], v[144:147]
    ds_read_b128 v[228:231], v5 offset:23552
    v_mfma_f32_16x16x32_bf16 v[76:79], v[160:163], v[188:191], v[76:79]
    s_add_u32 m0, s29, 62464
    s_nop 0
    buffer_load_dwordx4 v2, s[36:39], s26 offen lds
    v_mfma_f32_16x16x32_bf16 v[100:103], v[164:167], v[188:191], v[100:103]
    ds_read_b128 v[232:235], v5 offset:24576
    v_mfma_f32_16x16x32_bf16 v[124:127], v[168:171], v[188:191], v[124:127]
    ds_read_b128 v[236:239], v5 offset:25600
    v_mfma_f32_16x16x32_bf16 v[148:151], v[172:175], v[188:191], v[148:151]
    s_add_u32 m0, s29, 63488
    s_nop 0
    buffer_load_dwordx4 v2, s[36:39], s27 offen lds
    v_mfma_f32_16x16x32_bf16 v[80:83], v[160:163], v[192:195], v[80:83]
    s_add_u32 s24, s24, 1024
    s_add_u32 s44, s44, 1024
    s_add_u32 s25, s25, 1024
    s_add_u32 s26, s26, 1024
    s_add_u32 s27, s27, 1024
    v_mfma_f32_16x16x32_bf16 v[104:107], v[164:167], v[192:195], v[104:107]
    v_mfma_f32_16x16x32_bf16 v[128:131], v[168:171], v[192:195], v[128:131]
    v_mfma_f32_16x16x32_bf16 v[152:155], v[172:175], v[192:195], v[152:155]
    v_mfma_f32_16x16x32_bf16 v[84:87], v[160:163], v[196:199], v[84:87]
    v_mfma_f32_16x16x32_bf16 v[108:111], v[164:167], v[196:199], v[108:111]
    v_mfma_f32_16x16x32_bf16 v[132:135], v[168:171], v[196:199], v[132:135]
    v_mfma_f32_16x16x32_bf16 v[156:159], v[172:175], v[196:199], v[156:159]
    s_waitcnt vmcnt(5)
    s_barrier
    s_waitcnt lgkmcnt(0)
    v_mfma_f32_16x16x32_bf16 v[64:67], v[200:203], v[216:219], v[64:67]
    v_mfma_f32_16x16x32_bf16 v[88:91], v[204:207], v[216:219], v[88:91]
    ds_read_b128 v[160:163], v3 offset:40960
    v_mfma_f32_16x16x32_bf16 v[112:115], v[208:211], v[216:219], v[112:115]
    ds_read_b128 v[164:167], v3 offset:41984
    v_mfma_f32_16x16x32_bf16 v[136:139], v[212:215], v[216:219], v[136:139]
    s_add_u32 m0, s28, 0
    s_nop 0
    buffer_load_dwordx4 v2, s[8:11], s24 offen lds
    v_mfma_f32_16x16x32_bf16 v[68:71], v[200:203], v[220:223], v[68:71]
    ds_read_b128 v[168:171], v3 offset:45056
    v_mfma_f32_16x16x32_bf16 v[92:95], v[204:207], v[220:223], v[92:95]
    ds_read_b128 v[172:175], v3 offset:46080
    v_mfma_f32_16x16x32_bf16 v[116:119], v[208:211], v[220:223], v[116:119]
    s_add_u32 m0, s28, 4096
    s_nop 0
    buffer_load_dwordx4 v2, s[8:11], s44 offen lds
    v_mfma_f32_16x16x32_bf16 v[140:143], v[212:215], v[220:223], v[140:143]
    ds_read_b128 v[176:179], v5 offset:40960
    v_mfma_f32_16x16x32_bf16 v[72:75], v[200:203], v[224:227], v[72:75]
    ds_read_b128 v[180:183], v5 offset:41984
    v_mfma_f32_16x16x32_bf16 v[96:99], v[204:207], v[224:227], v[96:99]
    s_add_u32 m0, s29, 0
    s_nop 0
    buffer_load_dwordx4 v2, s[36:39], s25 offen lds
    v_mfma_f32_16x16x32_bf16 v[120:123], v[208:211], v[224:227], v[120:123]
    ds_read_b128 v[184:187], v5 offset:43008
    v_mfma_f32_16x16x32_bf16 v[144:147], v[212:215], v[224:227], v[144:147]
    ds_read_b128 v[188:191], v5 offset:44032
    v_mfma_f32_16x16x32_bf16 v[76:79], v[200:203], v[228:231], v[76:79]
    s_add_u32 m0, s29, 1024
    s_nop 0
    buffer_load_dwordx4 v2, s[36:39], s26 offen lds
    v_mfma_f32_16x16x32_bf16 v[100:103], v[204:207], v[228:231], v[100:103]
    ds_read_b128 v[192:195], v5 offset:45056
    v_mfma_f32_16x16x32_bf16 v[124:127], v[208:211], v[228:231], v[124:127]
    ds_read_b128 v[196:199], v5 offset:46080
    v_mfma_f32_16x16x32_bf16 v[148:151], v[212:215], v[228:231], v[148:151]
    s_add_u32 m0, s29, 2048
    s_nop 0
    buffer_load_dwordx4 v2, s[36:39], s27 offen lds
    v_mfma_f32_16x16x32_bf16 v[80:83], v[200:203], v[232:235], v[80:83]
    s_add_u32 s24, s24, 1024
    s_add_u32 s44, s44, 1024
    s_add_u32 s25, s25, 1024
    s_add_u32 s26, s26, 1024
    s_add_u32 s27, s27, 1024
    v_mfma_f32_16x16x32_bf16 v[104:107], v[204:207], v[232:235], v[104:107]
    v_mfma_f32_16x16x32_bf16 v[128:131], v[208:211], v[232:235], v[128:131]
    v_mfma_f32_16x16x32_bf16 v[152:155], v[212:215], v[232:235], v[152:155]
    v_mfma_f32_16x16x32_bf16 v[84:87], v[200:203], v[236:239], v[84:87]
    v_mfma_f32_16x16x32_bf16 v[108:111], v[204:207], v[236:239], v[108:111]
    v_mfma_f32_16x16x32_bf16 v[132:135], v[208:211], v[236:239], v[132:135]
    v_mfma_f32_16x16x32_bf16 v[156:159], v[212:215], v[236:239], v[156:159]
    s_waitcnt vmcnt(5)
    s_barrier
    s_waitcnt lgkmcnt(0)
    v_mfma_f32_16x16x32_bf16 v[64:67], v[160:163], v[176:179], v[64:67]
    v_mfma_f32_16x16x32_bf16 v[88:91], v[164:167], v[176:179], v[88:91]
    ds_read_b128 v[200:203], v6 offset:0
    v_mfma_f32_16x16x32_bf16 v[112:115], v[168:171], v[176:179], v[112:115]
    ds_read_b128 v[204:207], v6 offset:1024
    v_mfma_f32_16x16x32_bf16 v[136:139], v[172:175], v[176:179], v[136:139]
    s_add_u32 m0, s28, 20480
    s_nop 0
    buffer_load_dwordx4 v2, s[8:11], s24 offen lds
    v_mfma_f32_16x16x32_bf16 v[68:71], v[160:163], v[180:183], v[68:71]
    ds_read_b128 v[208:211], v6 offset:4096
    v_mfma_f32_16x16x32_bf16 v[92:95], v[164:167], v[180:183], v[92:95]
    ds_read_b128 v[212:215], v6 offset:5120
    v_mfma_f32_16x16x32_bf16 v[116:119], v[168:171], v[180:183], v[116:119]
    s_add_u32 m0, s28, 24576
    s_nop 0
    buffer_load_dwordx4 v2, s[8:11], s44 offen lds
    v_mfma_f32_16x16x32_bf16 v[140:143], v[172:175], v[180:183], v[140:143]
    ds_read_b128 v[216:219], v8 offset:0
    v_mfma_f32_16x16x32_bf16 v[72:75], v[160:163], v[184:187], v[72:75]
    ds_read_b128 v[220:223], v8 offset:1024
    v_mfma_f32_16x16x32_bf16 v[96:99], v[164:167], v[184:187], v[96:99]
    s_add_u32 m0, s29, 20480
    s_nop 0
    buffer_load_dwordx4 v2, s[36:39], s25 offen lds
    v_mfma_f32_16x16x32_bf16 v[120:123], v[168:171], v[184:187], v[120:123]
    ds_read_b128 v[224:227], v8 offset:2048
    v_mfma_f32_16x16x32_bf16 v[144:147], v[172:175], v[184:187], v[144:147]
    ds_read_b128 v[228:231], v8 offset:3072
    v_mfma_f32_16x16x32_bf16 v[76:79], v[160:163], v[188:191], v[76:79]
    s_add_u32 m0, s29, 21504
    s_nop 0
    buffer_load_dwordx4 v2, s[36:39], s26 offen lds
    v_mfma_f32_16x16x32_bf16 v[100:103], v[164:167], v[188:191], v[100:103]
    ds_read_b128 v[232:235], v8 offset:4096
    v_mfma_f32_16x16x32_bf16 v[124:127], v[168:171], v[188:191], v[124:127]
    ds_read_b128 v[236:239], v8 offset:5120
    v_mfma_f32_16x16x32_bf16 v[148:151], v[172:175], v[188:191], v[148:151]
    s_add_u32 m0, s29, 22528
    s_nop 0
    buffer_load_dwordx4 v2, s[36:39], s27 offen lds
    v_mfma_f32_16x16x32_bf16 v[80:83], v[160:163], v[192:195], v[80:83]
    s_add_u32 s24, s24, 1024
    s_add_u32 s44, s44, 1024
    s_add_u32 s25, s25, 1024
    s_add_u32 s26, s26, 1024
    s_add_u32 s27, s27, 1024
    v_mfma_f32_16x16x32_bf16 v[104:107], v[164:167], v[192:195], v[104:107]
    v_mfma_f32_16x16x32_bf16 v[128:131], v[168:171], v[192:195], v[128:131]
    v_mfma_f32_16x16x32_bf16 v[152:155], v[172:175], v[192:195], v[152:155]
    v_mfma_f32_16x16x32_bf16 v[84:87], v[160:163], v[196:199], v[84:87]
    v_mfma_f32_16x16x32_bf16 v[108:111], v[164:167], v[196:199], v[108:111]
    v_mfma_f32_16x16x32_bf16 v[132:135], v[168:171], v[196:199], v[132:135]
    v_mfma_f32_16x16x32_bf16 v[156:159], v[172:175], v[196:199], v[156:159]
    s_waitcnt vmcnt(5)
    s_barrier
    s_waitcnt lgkmcnt(0)
    v_mfma_f32_16x16x32_bf16 v[64:67], v[200:203], v[216:219], v[64:67]
    v_mfma_f32_16x16x32_bf16 v[88:91], v[204:207], v[216:219], v[88:91]
    ds_read_b128 v[160:163], v3 offset:0
    v_mfma_f32_16x16x32_bf16 v[112:115], v[208:211], v[216:219], v[112:115]
    ds_read_b128 v[164:167], v3 offset:1024
    v_mfma_f32_16x16x32_bf16 v[136:139], v[212:215], v[216:219], v[136:139]
    s_add_u32 m0, s28, 40960
    s_nop 0
    buffer_load_dwordx4 v2, s[8:11], s24 offen lds
    v_mfma_f32_16x16x32_bf16 v[68:71], v[200:203], v[220:223], v[68:71]
    ds_read_b128 v[168:171], v3 offset:4096
    v_mfma_f32_16x16x32_bf16 v[92:95], v[204:207], v[220:223], v[92:95]
    ds_read_b128 v[172:175], v3 offset:5120
    v_mfma_f32_16x16x32_bf16 v[116:119], v[208:211], v[220:223], v[116:119]
    s_add_u32 m0, s28, 45056
    s_nop 0
    buffer_load_dwordx4 v2, s[8:11], s44 offen lds
    v_mfma_f32_16x16x32_bf16 v[140:143], v[212:215], v[220:223], v[140:143]
    ds_read_b128 v[176:179], v5 offset:0
    v_mfma_f32_16x16x32_bf16 v[72:75], v[200:203], v[224:227], v[72:75]
    ds_read_b128 v[180:183], v5 offset:1024
    v_mfma_f32_16x16x32_bf16 v[96:99], v[204:207], v[224:227], v[96:99]
    s_add_u32 m0, s29, 40960
    s_nop 0
    buffer_load_dwordx4 v2, s[36:39], s25 offen lds
    v_mfma_f32_16x16x32_bf16 v[120:123], v[208:211], v[224:227], v[120:123]
    ds_read_b128 v[184:187], v5 offset:2048
    v_mfma_f32_16x16x32_bf16 v[144:147], v[212:215], v[224:227], v[144:147]
    ds_read_b128 v[188:191], v5 offset:3072
    v_mfma_f32_16x16x32_bf16 v[76:79], v[200:203], v[228:231], v[76:79]
    s_add_u32 m0, s29, 41984
    s_nop 0
    buffer_load_dwordx4 v2, s[36:39], s26 offen lds
    v_mfma_f32_16x16x32_bf16 v[100:103], v[204:207], v[228:231], v[100:103]
    ds_read_b128 v[192:195], v5 offset:4096
    v_mfma_f32_16x16x32_bf16 v[124:127], v[208:211], v[228:231], v[124:127]
    ds_read_b128 v[196:199], v5 offset:5120
    v_mfma_f32_16x16x32_bf16 v[148:151], v[212:215], v[228:231], v[148:151]
    s_add_u32 m0, s29, 43008
    s_nop 0
    buffer_load_dwordx4 v2, s[36:39], s27 offen lds
    v_mfma_f32_16x16x32_bf16 v[80:83], v[200:203], v[232:235], v[80:83]
    s_add_u32 s24, s24, 1024
    s_add_u32 s44, s44, 1024
    s_add_u32 s25, s25, 1024
    s_add_u32 s26, s26, 1024
    s_add_u32 s27, s27, 1024
    v_mfma_f32_16x16x32_bf16 v[104:107], v[204:207], v[232:235], v[104:107]
    v_mfma_f32_16x16x32_bf16 v[128:131], v[208:211], v[232:235], v[128:131]
    v_mfma_f32_16x16x32_bf16 v[152:155], v[212:215], v[232:235], v[152:155]
    v_mfma_f32_16x16x32_bf16 v[84:87], v[200:203], v[236:239], v[84:87]
    v_mfma_f32_16x16x32_bf16 v[108:111], v[204:207], v[236:239], v[108:111]
    v_mfma_f32_16x16x32_bf16 v[132:135], v[208:211], v[236:239], v[132:135]
    v_mfma_f32_16x16x32_bf16 v[156:159], v[212:215], v[236:239], v[156:159]
    s_waitcnt vmcnt(5)
    s_barrier
    s_waitcnt lgkmcnt(0)
    v_mfma_f32_16x16x32_bf16 v[64:67], v[160:163], v[176:179], v[64:67]
    v_mfma_f32_16x16x32_bf16 v[88:91], v[164:167], v[176:179], v[88:91]
    ds_read_b128 v[200:203], v3 offset:20480
    v_mfma_f32_16x16x32_bf16 v[112:115], v[168:171], v[176:179], v[112:115]
    ds_read_b128 v[204:207], v3 offset:21504
    v_mfma_f32_16x16x32_bf16 v[136:139], v[172:175], v[176:179], v[136:139]
    s_add_u32 m0, s28, 61440
    s_nop 0
    buffer_load_dwordx4 v2, s[8:11], s24 offen lds
    v_mfma_f32_16x16x32_bf16 v[68:71], v[160:163], v[180:183], v[68:71]
    ds_read_b128 v[208:211], v3 offset:24576
    v_mfma_f32_16x16x32_bf16 v[92:95], v[164:167], v[180:183], v[92:95]
    ds_read_b128 v[212:215], v3 offset:25600
    v_mfma_f32_16x16x32_bf16 v[116:119], v[168:171], v[180:183], v[116:119]
    s_add_u32 m0, s28, 65536
    s_nop 0
    buffer_load_dwordx4 v2, s[8:11], s44 offen lds
    v_mfma_f32_16x16x32_bf16 v[140:143], v[172:175], v[180:183], v[140:143]
    ds_read_b128 v[216:219], v5 offset:20480
    v_mfma_f32_16x16x32_bf16 v[72:75], v[160:163], v[184:187], v[72:75]
    ds_read_b128 v[220:223], v5 offset:21504
    v_mfma_f32_16x16x32_bf16 v[96:99], v[164:167], v[184:187], v[96:99]
    s_add_u32 m0, s29, 61440
    s_nop 0
    buffer_load_dwordx4 v2, s[36:39], s25 offen lds
    v_mfma_f32_16x16x32_bf16 v[120:123], v[168:171], v[184:187], v[120:123]
    ds_read_b128 v[224:227], v5 offset:22528
    v_mfma_f32_16x16x32_bf16 v[144:147], v[172:175], v[184:187], v[144:147]
    ds_read_b128 v[228:231], v5 offset:23552
    v_mfma_f32_16x16x32_bf16 v[76:79], v[160:163], v[188:191], v[76:79]
    s_add_u32 m0, s29, 62464
    s_nop 0
    buffer_load_dwordx4 v2, s[36:39], s26 offen lds
    v_mfma_f32_16x16x32_bf16 v[100:103], v[164:167], v[188:191], v[100:103]
    ds_read_b128 v[232:235], v5 offset:24576
    v_mfma_f32_16x16x32_bf16 v[124:127], v[168:171], v[188:191], v[124:127]
    ds_read_b128 v[236:239], v5 offset:25600
    v_mfma_f32_16x16x32_bf16 v[148:151], v[172:175], v[188:191], v[148:151]
    s_add_u32 m0, s29, 63488
    s_nop 0
    buffer_load_dwordx4 v2, s[36:39], s27 offen lds
    v_mfma_f32_16x16x32_bf16 v[80:83], v[160:163], v[192:195], v[80:83]
    s_add_u32 s24, s24, 1024
    s_add_u32 s44, s44, 1024
    s_add_u32 s25, s25, 1024
    s_add_u32 s26, s26, 1024
    s_add_u32 s27, s27, 1024
    v_mfma_f32_16x16x32_bf16 v[104:107], v[164:167], v[192:195], v[104:107]
    v_mfma_f32_16x16x32_bf16 v[128:131], v[168:171], v[192:195], v[128:131]
    v_mfma_f32_16x16x32_bf16 v[152:155], v[172:175], v[192:195], v[152:155]
    v_mfma_f32_16x16x32_bf16 v[84:87], v[160:163], v[196:199], v[84:87]
    v_mfma_f32_16x16x32_bf16 v[108:111], v[164:167], v[196:199], v[108:111]
    v_mfma_f32_16x16x32_bf16 v[132:135], v[168:171], v[196:199], v[132:135]
    v_mfma_f32_16x16x32_bf16 v[156:159], v[172:175], v[196:199], v[156:159]
    s_waitcnt vmcnt(5)
    s_barrier
    s_waitcnt lgkmcnt(0)
    v_mfma_f32_16x16x32_bf16 v[64:67], v[200:203], v[216:219], v[64:67]
    v_mfma_f32_16x16x32_bf16 v[88:91], v[204:207], v[216:219], v[88:91]
    ds_read_b128 v[160:163], v3 offset:40960
    v_mfma_f32_16x16x32_bf16 v[112:115], v[208:211], v[216:219], v[112:115]
    ds_read_b128 v[164:167], v3 offset:41984
    v_mfma_f32_16x16x32_bf16 v[136:139], v[212:215], v[216:219], v[136:139]
    s_add_u32 m0, s28, 0
    s_nop 0
    buffer_load_dwordx4 v2, s[8:11], s24 offen lds
    v_mfma_f32_16x16x32_bf16 v[68:71], v[200:203], v[220:223], v[68:71]
    ds_read_b128 v[168:171], v3 offset:45056
    v_mfma_f32_16x16x32_bf16 v[92:95], v[204:207], v[220:223], v[92:95]
    ds_read_b128 v[172:175], v3 offset:46080
    v_mfma_f32_16x16x32_bf16 v[116:119], v[208:211], v[220:223], v[116:119]
    s_add_u32 m0, s28, 4096
    s_nop 0
    buffer_load_dwordx4 v2, s[8:11], s44 offen lds
    v_mfma_f32_16x16x32_bf16 v[140:143], v[212:215], v[220:223], v[140:143]
    ds_read_b128 v[176:179], v5 offset:40960
    v_mfma_f32_16x16x32_bf16 v[72:75], v[200:203], v[224:227], v[72:75]
    ds_read_b128 v[180:183], v5 offset:41984
    v_mfma_f32_16x16x32_bf16 v[96:99], v[204:207], v[224:227], v[96:99]
    s_add_u32 m0, s29, 0
    s_nop 0
    buffer_load_dwordx4 v2, s[36:39], s25 offen lds
    v_mfma_f32_16x16x32_bf16 v[120:123], v[208:211], v[224:227], v[120:123]
    ds_read_b128 v[184:187], v5 offset:43008
    v_mfma_f32_16x16x32_bf16 v[144:147], v[212:215], v[224:227], v[144:147]
    ds_read_b128 v[188:191], v5 offset:44032
    v_mfma_f32_16x16x32_bf16 v[76:79], v[200:203], v[228:231], v[76:79]
    s_add_u32 m0, s29, 1024
    s_nop 0
    buffer_load_dwordx4 v2, s[36:39], s26 offen lds
    v_mfma_f32_16x16x32_bf16 v[100:103], v[204:207], v[228:231], v[100:103]
    ds_read_b128 v[192:195], v5 offset:45056
    v_mfma_f32_16x16x32_bf16 v[124:127], v[208:211], v[228:231], v[124:127]
    ds_read_b128 v[196:199], v5 offset:46080
    v_mfma_f32_16x16x32_bf16 v[148:151], v[212:215], v[228:231], v[148:151]
    s_add_u32 m0, s29, 2048
    s_nop 0
    buffer_load_dwordx4 v2, s[36:39], s27 offen lds
    v_mfma_f32_16x16x32_bf16 v[80:83], v[200:203], v[232:235], v[80:83]
    s_add_u32 s24, s24, 1024
    s_add_u32 s44, s44, 1024
    s_add_u32 s25, s25, 1024
    s_add_u32 s26, s26, 1024
    s_add_u32 s27, s27, 1024
    v_mfma_f32_16x16x32_bf16 v[104:107], v[204:207], v[232:235], v[104:107]
    v_mfma_f32_16x16x32_bf16 v[128:131], v[208:211], v[232:235], v[128:131]
    v_mfma_f32_16x16x32_bf16 v[152:155], v[212:215], v[232:235], v[152:155]
    v_mfma_f32_16x16x32_bf16 v[84:87], v[200:203], v[236:239], v[84:87]
    v_mfma_f32_16x16x32_bf16 v[108:111], v[204:207], v[236:239], v[108:111]
    v_mfma_f32_16x16x32_bf16 v[132:135], v[208:211], v[236:239], v[132:135]
    v_mfma_f32_16x16x32_bf16 v[156:159], v[212:215], v[236:239], v[156:159]
    s_waitcnt vmcnt(5)
    s_barrier
    s_waitcnt lgkmcnt(0)
    v_mfma_f32_16x16x32_bf16 v[64:67], v[160:163], v[176:179], v[64:67]
    v_mfma_f32_16x16x32_bf16 v[88:91], v[164:167], v[176:179], v[88:91]
    ds_read_b128 v[200:203], v6 offset:0
    v_mfma_f32_16x16x32_bf16 v[112:115], v[168:171], v[176:179], v[112:115]
    ds_read_b128 v[204:207], v6 offset:1024
    v_mfma_f32_16x16x32_bf16 v[136:139], v[172:175], v[176:179], v[136:139]
    s_add_u32 m0, s28, 20480
    s_nop 0
    buffer_load_dwordx4 v2, s[8:11], s24 offen lds
    v_mfma_f32_16x16x32_bf16 v[68:71], v[160:163], v[180:183], v[68:71]
    ds_read_b128 v[208:211], v6 offset:4096
    v_mfma_f32_16x16x32_bf16 v[92:95], v[164:167], v[180:183], v[92:95]
    ds_read_b128 v[212:215], v6 offset:5120
    v_mfma_f32_16x16x32_bf16 v[116:119], v[168:171], v[180:183], v[116:119]
    s_add_u32 m0, s28, 24576
    s_nop 0
    buffer_load_dwordx4 v2, s[8:11], s44 offen lds
    v_mfma_f32_16x16x32_bf16 v[140:143], v[172:175], v[180:183], v[140:143]
    ds_read_b128 v[216:219], v8 offset:0
    v_mfma_f32_16x16x32_bf16 v[72:75], v[160:163], v[184:187], v[72:75]
    ds_read_b128 v[220:223], v8 offset:1024
    v_mfma_f32_16x16x32_bf16 v[96:99], v[164:167], v[184:187], v[96:99]
    s_add_u32 m0, s29, 20480
    s_nop 0
    buffer_load_dwordx4 v2, s[36:39], s25 offen lds
    v_mfma_f32_16x16x32_bf16 v[120:123], v[168:171], v[184:187], v[120:123]
    ds_read_b128 v[224:227], v8 offset:2048
    v_mfma_f32_16x16x32_bf16 v[144:147], v[172:175], v[184:187], v[144:147]
    ds_read_b128 v[228:231], v8 offset:3072
    v_mfma_f32_16x16x32_bf16 v[76:79], v[160:163], v[188:191], v[76:79]
    s_add_u32 m0, s29, 21504
    s_nop 0
    buffer_load_dwordx4 v2, s[36:39], s26 offen lds
    v_mfma_f32_16x16x32_bf16 v[100:103], v[164:167], v[188:191], v[100:103]
    ds_read_b128 v[232:235], v8 offset:4096
    v_mfma_f32_16x16x32_bf16 v[124:127], v[168:171], v[188:191], v[124:127]
    ds_read_b128 v[236:239], v8 offset:5120
    v_mfma_f32_16x16x32_bf16 v[148:151], v[172:175], v[188:191], v[148:151]
    s_add_u32 m0, s29, 22528
    s_nop 0
    buffer_load_dwordx4 v2, s[36:39], s27 offen lds
    v_mfma_f32_16x16x32_bf16 v[80:83], v[160:163], v[192:195], v[80:83]
    s_add_u32 s24, s24, 1024
    s_add_u32 s44, s44, 1024
    s_add_u32 s25, s25, 1024
    s_add_u32 s26, s26, 1024
    s_add_u32 s27, s27, 1024
    v_mfma_f32_16x16x32_bf16 v[104:107], v[164:167], v[192:195], v[104:107]
    v_mfma_f32_16x16x32_bf16 v[128:131], v[168:171], v[192:195], v[128:131]
    v_mfma_f32_16x16x32_bf16 v[152:155], v[172:175], v[192:195], v[152:155]
    v_mfma_f32_16x16x32_bf16 v[84:87], v[160:163], v[196:199], v[84:87]
    v_mfma_f32_16x16x32_bf16 v[108:111], v[164:167], v[196:199], v[108:111]
    v_mfma_f32_16x16x32_bf16 v[132:135], v[168:171], v[196:199], v[132:135]
    v_mfma_f32_16x16x32_bf16 v[156:159], v[172:175], v[196:199], v[156:159]
    s_waitcnt vmcnt(5)
    s_barrier
    s_waitcnt lgkmcnt(0)
    v_mfma_f32_16x16x32_bf16 v[64:67], v[200:203], v[216:219], v[64:67]
    v_mfma_f32_16x16x32_bf16 v[88:91], v[204:207], v[216:219], v[88:91]
    ds_read_b128 v[160:163], v3 offset:0
    v_mfma_f32_16x16x32_bf16 v[112:115], v[208:211], v[216:219], v[112:115]
    ds_read_b128 v[164:167], v3 offset:1024
    v_mfma_f32_16x16x32_bf16 v[136:139], v[212:215], v[216:219], v[136:139]
    s_add_u32 m0, s28, 40960
    s_nop 0
    buffer_load_dwordx4 v2, s[8:11], s24 offen lds
    v_mfma_f32_16x16x32_bf16 v[68:71], v[200:203], v[220:223], v[68:71]
    ds_read_b128 v[168:171], v3 offset:4096
    v_mfma_f32_16x16x32_bf16 v[92:95], v[204:207], v[220:223], v[92:95]
    ds_read_b128 v[172:175], v3 offset:5120
    v_mfma_f32_16x16x32_bf16 v[116:119], v[208:211], v[220:223], v[116:119]
    s_add_u32 m0, s28, 45056
    s_nop 0
    buffer_load_dwordx4 v2, s[8:11], s44 offen lds
    v_mfma_f32_16x16x32_bf16 v[140:143], v[212:215], v[220:223], v[140:143]
    ds_read_b128 v[176:179], v5 offset:0
    v_mfma_f32_16x16x32_bf16 v[72:75], v[200:203], v[224:227], v[72:75]
    ds_read_b128 v[180:183], v5 offset:1024
    v_mfma_f32_16x16x32_bf16 v[96:99], v[204:207], v[224:227], v[96:99]
    s_add_u32 m0, s29, 40960
    s_nop 0
    buffer_load_dwordx4 v2, s[36:39], s25 offen lds
    v_mfma_f32_16x16x32_bf16 v[120:123], v[208:211], v[224:227], v[120:123]
    ds_read_b128 v[184:187], v5 offset:2048
    v_mfma_f32_16x16x32_bf16 v[144:147], v[212:215], v[224:227], v[144:147]
    ds_read_b128 v[188:191], v5 offset:3072
    v_mfma_f32_16x16x32_bf16 v[76:79], v[200:203], v[228:231], v[76:79]
    s_add_u32 m0, s29, 41984
    s_nop 0
    buffer_load_dwordx4 v2, s[36:39], s26 offen lds
    v_mfma_f32_16x16x32_bf16 v[100:103], v[204:207], v[228:231], v[100:103]
    ds_read_b128 v[192:195], v5 offset:4096
    v_mfma_f32_16x16x32_bf16 v[124:127], v[208:211], v[228:231], v[124:127]
    ds_read_b128 v[196:199], v5 offset:5120
    v_mfma_f32_16x16x32_bf16 v[148:151], v[212:215], v[228:231], v[148:151]
    s_add_u32 m0, s29, 43008
    s_nop 0
    buffer_load_dwordx4 v2, s[36:39], s27 offen lds
    v_mfma_f32_16x16x32_bf16 v[80:83], v[200:203], v[232:235], v[80:83]
    s_add_u32 s24, s24, 1024
    s_add_u32 s44, s44, 1024
    s_add_u32 s25, s25, 1024
    s_add_u32 s26, s26, 1024
    s_add_u32 s27, s27, 1024
    v_mfma_f32_16x16x32_bf16 v[104:107], v[204:207], v[232:235], v[104:107]
    v_mfma_f32_16x16x32_bf16 v[128:131], v[208:211], v[232:235], v[128:131]
    v_mfma_f32_16x16x32_bf16 v[152:155], v[212:215], v[232:235], v[152:155]
    v_mfma_f32_16x16x32_bf16 v[84:87], v[200:203], v[236:239], v[84:87]
    v_mfma_f32_16x16x32_bf16 v[108:111], v[204:207], v[236:239], v[108:111]
    v_mfma_f32_16x16x32_bf16 v[132:135], v[208:211], v[236:239], v[132:135]
    v_mfma_f32_16x16x32_bf16 v[156:159], v[212:215], v[236:239], v[156:159]
    s_waitcnt vmcnt(5)
    s_barrier
    s_waitcnt lgkmcnt(0)
    v_mfma_f32_16x16x32_bf16 v[64:67], v[160:163], v[176:179], v[64:67]
    v_mfma_f32_16x16x32_bf16 v[88:91], v[164:167], v[176:179], v[88:91]
    ds_read_b128 v[200:203], v3 offset:20480
    v_mfma_f32_16x16x32_bf16 v[112:115], v[168:171], v[176:179], v[112:115]
    ds_read_b128 v[204:207], v3 offset:21504
    v_mfma_f32_16x16x32_bf16 v[136:139], v[172:175], v[176:179], v[136:139]
    s_add_u32 m0, s28, 61440
    s_nop 0
    buffer_load_dwordx4 v2, s[8:11], s24 offen lds
    v_mfma_f32_16x16x32_bf16 v[68:71], v[160:163], v[180:183], v[68:71]
    ds_read_b128 v[208:211], v3 offset:24576
    v_mfma_f32_16x16x32_bf16 v[92:95], v[164:167], v[180:183], v[92:95]
    ds_read_b128 v[212:215], v3 offset:25600
    v_mfma_f32_16x16x32_bf16 v[116:119], v[168:171], v[180:183], v[116:119]
    s_add_u32 m0, s28, 65536
    s_nop 0
    buffer_load_dwordx4 v2, s[8:11], s44 offen lds
    v_mfma_f32_16x16x32_bf16 v[140:143], v[172:175], v[180:183], v[140:143]
    ds_read_b128 v[216:219], v5 offset:20480
    v_mfma_f32_16x16x32_bf16 v[72:75], v[160:163], v[184:187], v[72:75]
    ds_read_b128 v[220:223], v5 offset:21504
    v_mfma_f32_16x16x32_bf16 v[96:99], v[164:167], v[184:187], v[96:99]
    s_add_u32 m0, s29, 61440
    s_nop 0
    buffer_load_dwordx4 v2, s[36:39], s25 offen lds
    v_mfma_f32_16x16x32_bf16 v[120:123], v[168:171], v[184:187], v[120:123]
    ds_read_b128 v[224:227], v5 offset:22528
    v_mfma_f32_16x16x32_bf16 v[144:147], v[172:175], v[184:187], v[144:147]
    ds_read_b128 v[228:231], v5 offset:23552
    v_mfma_f32_16x16x32_bf16 v[76:79], v[160:163], v[188:191], v[76:79]
    s_add_u32 m0, s29, 62464
    s_nop 0
    buffer_load_dwordx4 v2, s[36:39], s26 offen lds
    v_mfma_f32_16x16x32_bf16 v[100:103], v[164:167], v[188:191], v[100:103]
    ds_read_b128 v[232:235], v5 offset:24576
    v_mfma_f32_16x16x32_bf16 v[124:127], v[168:171], v[188:191], v[124:127]
    ds_read_b128 v[236:239], v5 offset:25600
    v_mfma_f32_16x16x32_bf16 v[148:151], v[172:175], v[188:191], v[148:151]
    s_add_u32 m0, s29, 63488
    s_nop 0
    buffer_load_dwordx4 v2, s[36:39], s27 offen lds
    v_mfma_f32_16x16x32_bf16 v[80:83], v[160:163], v[192:195], v[80:83]
    s_add_u32 s24, s24, 1024
    s_add_u32 s44, s44, 1024
    s_add_u32 s25, s25, 1024
    s_add_u32 s26, s26, 1024
    s_add_u32 s27, s27, 1024
    v_mfma_f32_16x16x32_bf16 v[104:107], v[164:167], v[192:195], v[104:107]
    v_mfma_f32_16x16x32_bf16 v[128:131], v[168:171], v[192:195], v[128:131]
    v_mfma_f32_16x16x32_bf16 v[152:155], v[172:175], v[192:195], v[152:155]
    v_mfma_f32_16x16x32_bf16 v[84:87], v[160:163], v[196:199], v[84:87]
    v_mfma_f32_16x16x32_bf16 v[108:111], v[164:167], v[196:199], v[108:111]
    v_mfma_f32_16x16x32_bf16 v[132:135], v[168:171], v[196:199], v[132:135]
    v_mfma_f32_16x16x32_bf16 v[156:159], v[172:175], v[196:199], v[156:159]
    s_waitcnt vmcnt(5)
    s_barrier
    s_waitcnt lgkmcnt(0)
    v_mfma_f32_16x16x32_bf16 v[64:67], v[200:203], v[216:219], v[64:67]
    v_mfma_f32_16x16x32_bf16 v[88:91], v[204:207], v[216:219], v[88:91]
    ds_read_b128 v[160:163], v3 offset:40960
    v_mfma_f32_16x16x32_bf16 v[112:115], v[208:211], v[216:219], v[112:115]
    ds_read_b128 v[164:167], v3 offset:41984
    v_mfma_f32_16x16x32_bf16 v[136:139], v[212:215], v[216:219], v[136:139]
    s_add_u32 m0, s28, 0
    s_nop 0
    buffer_load_dwordx4 v2, s[8:11], s24 offen lds
    v_mfma_f32_16x16x32_bf16 v[68:71], v[200:203], v[220:223], v[68:71]
    ds_read_b128 v[168:171], v3 offset:45056
    v_mfma_f32_16x16x32_bf16 v[92:95], v[204:207], v[220:223], v[92:95]
    ds_read_b128 v[172:175], v3 offset:46080
    v_mfma_f32_16x16x32_bf16 v[116:119], v[208:211], v[220:223], v[116:119]
    s_add_u32 m0, s28, 4096
    s_nop 0
    buffer_load_dwordx4 v2, s[8:11], s44 offen lds
    v_mfma_f32_16x16x32_bf16 v[140:143], v[212:215], v[220:223], v[140:143]
    ds_read_b128 v[176:179], v5 offset:40960
    v_mfma_f32_16x16x32_bf16 v[72:75], v[200:203], v[224:227], v[72:75]
    ds_read_b128 v[180:183], v5 offset:41984
    v_mfma_f32_16x16x32_bf16 v[96:99], v[204:207], v[224:227], v[96:99]
    s_add_u32 m0, s29, 0
    s_nop 0
    buffer_load_dwordx4 v2, s[36:39], s25 offen lds
    v_mfma_f32_16x16x32_bf16 v[120:123], v[208:211], v[224:227], v[120:123]
    ds_read_b128 v[184:187], v5 offset:43008
    v_mfma_f32_16x16x32_bf16 v[144:147], v[212:215], v[224:227], v[144:147]
    ds_read_b128 v[188:191], v5 offset:44032
    v_mfma_f32_16x16x32_bf16 v[76:79], v[200:203], v[228:231], v[76:79]
    s_add_u32 m0, s29, 1024
    s_nop 0
    buffer_load_dwordx4 v2, s[36:39], s26 offen lds
    v_mfma_f32_16x16x32_bf16 v[100:103], v[204:207], v[228:231], v[100:103]
    ds_read_b128 v[192:195], v5 offset:45056
    v_mfma_f32_16x16x32_bf16 v[124:127], v[208:211], v[228:231], v[124:127]
    ds_read_b128 v[196:199], v5 offset:46080
    v_mfma_f32_16x16x32_bf16 v[148:151], v[212:215], v[228:231], v[148:151]
    s_add_u32 m0, s29, 2048
    s_nop 0
    buffer_load_dwordx4 v2, s[36:39], s27 offen lds
    v_mfma_f32_16x16x32_bf16 v[80:83], v[200:203], v[232:235], v[80:83]
    s_add_u32 s24, s24, 1024
    s_add_u32 s44, s44, 1024
    s_add_u32 s25, s25, 1024
    s_add_u32 s26, s26, 1024
    s_add_u32 s27, s27, 1024
    v_mfma_f32_16x16x32_bf16 v[104:107], v[204:207], v[232:235], v[104:107]
    v_mfma_f32_16x16x32_bf16 v[128:131], v[208:211], v[232:235], v[128:131]
    v_mfma_f32_16x16x32_bf16 v[152:155], v[212:215], v[232:235], v[152:155]
    v_mfma_f32_16x16x32_bf16 v[84:87], v[200:203], v[236:239], v[84:87]
    v_mfma_f32_16x16x32_bf16 v[108:111], v[204:207], v[236:239], v[108:111]
    v_mfma_f32_16x16x32_bf16 v[132:135], v[208:211], v[236:239], v[132:135]
    v_mfma_f32_16x16x32_bf16 v[156:159], v[212:215], v[236:239], v[156:159]
    s_waitcnt vmcnt(5)
    s_barrier
    s_waitcnt lgkmcnt(0)
    v_mfma_f32_16x16x32_bf16 v[64:67], v[160:163], v[176:179], v[64:67]
    v_mfma_f32_16x16x32_bf16 v[88:91], v[164:167], v[176:179], v[88:91]
    ds_read_b128 v[200:203], v6 offset:0
    v_mfma_f32_16x16x32_bf16 v[112:115], v[168:171], v[176:179], v[112:115]
    ds_read_b128 v[204:207], v6 offset:1024
    v_mfma_f32_16x16x32_bf16 v[136:139], v[172:175], v[176:179], v[136:139]
    s_add_u32 m0, s28, 20480
    s_nop 0
    buffer_load_dwordx4 v2, s[8:11], s24 offen lds
    v_mfma_f32_16x16x32_bf16 v[68:71], v[160:163], v[180:183], v[68:71]
    ds_read_b128 v[208:211], v6 offset:4096
    v_mfma_f32_16x16x32_bf16 v[92:95], v[164:167], v[180:183], v[92:95]
    ds_read_b128 v[212:215], v6 offset:5120
    v_mfma_f32_16x16x32_bf16 v[116:119], v[168:171], v[180:183], v[116:119]
    s_add_u32 m0, s28, 24576
    s_nop 0
    buffer_load_dwordx4 v2, s[8:11], s44 offen lds
    v_mfma_f32_16x16x32_bf16 v[140:143], v[172:175], v[180:183], v[140:143]
    ds_read_b128 v[216:219], v8 offset:0
    v_mfma_f32_16x16x32_bf16 v[72:75], v[160:163], v[184:187], v[72:75]
    ds_read_b128 v[220:223], v8 offset:1024
    v_mfma_f32_16x16x32_bf16 v[96:99], v[164:167], v[184:187], v[96:99]
    s_add_u32 m0, s29, 20480
    s_nop 0
    buffer_load_dwordx4 v2, s[36:39], s25 offen lds
    v_mfma_f32_16x16x32_bf16 v[120:123], v[168:171], v[184:187], v[120:123]
    ds_read_b128 v[224:227], v8 offset:2048
    v_mfma_f32_16x16x32_bf16 v[144:147], v[172:175], v[184:187], v[144:147]
    ds_read_b128 v[228:231], v8 offset:3072
    v_mfma_f32_16x16x32_bf16 v[76:79], v[160:163], v[188:191], v[76:79]
    s_add_u32 m0, s29, 21504
    s_nop 0
    buffer_load_dwordx4 v2, s[36:39], s26 offen lds
    v_mfma_f32_16x16x32_bf16 v[100:103], v[164:167], v[188:191], v[100:103]
    ds_read_b128 v[232:235], v8 offset:4096
    v_mfma_f32_16x16x32_bf16 v[124:127], v[168:171], v[188:191], v[124:127]
    ds_read_b128 v[236:239], v8 offset:5120
    v_mfma_f32_16x16x32_bf16 v[148:151], v[172:175], v[188:191], v[148:151]
    s_add_u32 m0, s29, 22528
    s_nop 0
    buffer_load_dwordx4 v2, s[36:39], s27 offen lds
    v_mfma_f32_16x16x32_bf16 v[80:83], v[160:163], v[192:195], v[80:83]
    s_add_u32 s24, s24, 1024
    s_add_u32 s44, s44, 1024
    s_add_u32 s25, s25, 1024
    s_add_u32 s26, s26, 1024
    s_add_u32 s27, s27, 1024
    v_mfma_f32_16x16x32_bf16 v[104:107], v[164:167], v[192:195], v[104:107]
    v_mfma_f32_16x16x32_bf16 v[128:131], v[168:171], v[192:195], v[128:131]
    v_mfma_f32_16x16x32_bf16 v[152:155], v[172:175], v[192:195], v[152:155]
    v_mfma_f32_16x16x32_bf16 v[84:87], v[160:163], v[196:199], v[84:87]
    v_mfma_f32_16x16x32_bf16 v[108:111], v[164:167], v[196:199], v[108:111]
    v_mfma_f32_16x16x32_bf16 v[132:135], v[168:171], v[196:199], v[132:135]
    v_mfma_f32_16x16x32_bf16 v[156:159], v[172:175], v[196:199], v[156:159]
    s_waitcnt vmcnt(5)
    s_barrier
    s_waitcnt lgkmcnt(0)
    v_mfma_f32_16x16x32_bf16 v[64:67], v[200:203], v[216:219], v[64:67]
    v_mfma_f32_16x16x32_bf16 v[88:91], v[204:207], v[216:219], v[88:91]
    ds_read_b128 v[160:163], v3 offset:0
    v_mfma_f32_16x16x32_bf16 v[112:115], v[208:211], v[216:219], v[112:115]
    ds_read_b128 v[164:167], v3 offset:1024
    v_mfma_f32_16x16x32_bf16 v[136:139], v[212:215], v[216:219], v[136:139]
    s_add_u32 m0, s28, 40960
    s_nop 0
    buffer_load_dwordx4 v2, s[8:11], s24 offen lds
    v_mfma_f32_16x16x32_bf16 v[68:71], v[200:203], v[220:223], v[68:71]
    ds_read_b128 v[168:171], v3 offset:4096
    v_mfma_f32_16x16x32_bf16 v[92:95], v[204:207], v[220:223], v[92:95]
    ds_read_b128 v[172:175], v3 offset:5120
    v_mfma_f32_16x16x32_bf16 v[116:119], v[208:211], v[220:223], v[116:119]
    s_add_u32 m0, s28, 45056
    s_nop 0
    buffer_load_dwordx4 v2, s[8:11], s44 offen lds
    v_mfma_f32_16x16x32_bf16 v[140:143], v[212:215], v[220:223], v[140:143]
    ds_read_b128 v[176:179], v5 offset:0
    v_mfma_f32_16x16x32_bf16 v[72:75], v[200:203], v[224:227], v[72:75]
    ds_read_b128 v[180:183], v5 offset:1024
    v_mfma_f32_16x16x32_bf16 v[96:99], v[204:207], v[224:227], v[96:99]
    s_add_u32 m0, s29, 40960
    s_nop 0
    buffer_load_dwordx4 v2, s[36:39], s25 offen lds
    v_mfma_f32_16x16x32_bf16 v[120:123], v[208:211], v[224:227], v[120:123]
    ds_read_b128 v[184:187], v5 offset:2048
    v_mfma_f32_16x16x32_bf16 v[144:147], v[212:215], v[224:227], v[144:147]
    ds_read_b128 v[188:191], v5 offset:3072
    v_mfma_f32_16x16x32_bf16 v[76:79], v[200:203], v[228:231], v[76:79]
    s_add_u32 m0, s29, 41984
    s_nop 0
    buffer_load_dwordx4 v2, s[36:39], s26 offen lds
    v_mfma_f32_16x16x32_bf16 v[100:103], v[204:207], v[228:231], v[100:103]
    ds_read_b128 v[192:195], v5 offset:4096
    v_mfma_f32_16x16x32_bf16 v[124:127], v[208:211], v[228:231], v[124:127]
    ds_read_b128 v[196:199], v5 offset:5120
    v_mfma_f32_16x16x32_bf16 v[148:151], v[212:215], v[228:231], v[148:151]
    s_add_u32 m0, s29, 43008
    s_nop 0
    buffer_load_dwordx4 v2, s[36:39], s27 offen lds
    v_mfma_f32_16x16x32_bf16 v[80:83], v[200:203], v[232:235], v[80:83]
    s_add_u32 s24, s24, 1024
    s_add_u32 s44, s44, 1024
    s_add_u32 s25, s25, 1024
    s_add_u32 s26, s26, 1024
    s_add_u32 s27, s27, 1024
    v_mfma_f32_16x16x32_bf16 v[104:107], v[204:207], v[232:235], v[104:107]
    v_mfma_f32_16x16x32_bf16 v[128:131], v[208:211], v[232:235], v[128:131]
    v_mfma_f32_16x16x32_bf16 v[152:155], v[212:215], v[232:235], v[152:155]
    v_mfma_f32_16x16x32_bf16 v[84:87], v[200:203], v[236:239], v[84:87]
    v_mfma_f32_16x16x32_bf16 v[108:111], v[204:207], v[236:239], v[108:111]
    v_mfma_f32_16x16x32_bf16 v[132:135], v[208:211], v[236:239], v[132:135]
    v_mfma_f32_16x16x32_bf16 v[156:159], v[212:215], v[236:239], v[156:159]
    s_waitcnt vmcnt(5)
    s_barrier
    s_waitcnt lgkmcnt(0)
    v_mfma_f32_16x16x32_bf16 v[64:67], v[160:163], v[176:179], v[64:67]
    v_mfma_f32_16x16x32_bf16 v[88:91], v[164:167], v[176:179], v[88:91]
    ds_read_b128 v[200:203], v3 offset:20480
    v_mfma_f32_16x16x32_bf16 v[112:115], v[168:171], v[176:179], v[112:115]
    ds_read_b128 v[204:207], v3 offset:21504
    v_mfma_f32_16x16x32_bf16 v[136:139], v[172:175], v[176:179], v[136:139]
    s_add_u32 m0, s28, 61440
    s_nop 0
    buffer_load_dwordx4 v2, s[8:11], s24 offen lds
    v_mfma_f32_16x16x32_bf16 v[68:71], v[160:163], v[180:183], v[68:71]
    ds_read_b128 v[208:211], v3 offset:24576
    v_mfma_f32_16x16x32_bf16 v[92:95], v[164:167], v[180:183], v[92:95]
    ds_read_b128 v[212:215], v3 offset:25600
    v_mfma_f32_16x16x32_bf16 v[116:119], v[168:171], v[180:183], v[116:119]
    s_add_u32 m0, s28, 65536
    s_nop 0
    buffer_load_dwordx4 v2, s[8:11], s44 offen lds
    v_mfma_f32_16x16x32_bf16 v[140:143], v[172:175], v[180:183], v[140:143]
    ds_read_b128 v[216:219], v5 offset:20480
    v_mfma_f32_16x16x32_bf16 v[72:75], v[160:163], v[184:187], v[72:75]
    ds_read_b128 v[220:223], v5 offset:21504
    v_mfma_f32_16x16x32_bf16 v[96:99], v[164:167], v[184:187], v[96:99]
    s_add_u32 m0, s29, 61440
    s_nop 0
    buffer_load_dwordx4 v2, s[36:39], s25 offen lds
    v_mfma_f32_16x16x32_bf16 v[120:123], v[168:171], v[184:187], v[120:123]
    ds_read_b128 v[224:227], v5 offset:22528
    v_mfma_f32_16x16x32_bf16 v[144:147], v[172:175], v[184:187], v[144:147]
    ds_read_b128 v[228:231], v5 offset:23552
    v_mfma_f32_16x16x32_bf16 v[76:79], v[160:163], v[188:191], v[76:79]
    s_add_u32 m0, s29, 62464
    s_nop 0
    buffer_load_dwordx4 v2, s[36:39], s26 offen lds
    v_mfma_f32_16x16x32_bf16 v[100:103], v[164:167], v[188:191], v[100:103]
    ds_read_b128 v[232:235], v5 offset:24576
    v_mfma_f32_16x16x32_bf16 v[124:127], v[168:171], v[188:191], v[124:127]
    ds_read_b128 v[236:239], v5 offset:25600
    v_mfma_f32_16x16x32_bf16 v[148:151], v[172:175], v[188:191], v[148:151]
    s_add_u32 m0, s29, 63488
    s_nop 0
    buffer_load_dwordx4 v2, s[36:39], s27 offen lds
    v_mfma_f32_16x16x32_bf16 v[80:83], v[160:163], v[192:195], v[80:83]
    s_add_u32 s24, s24, 1024
    s_add_u32 s44, s44, 1024
    s_add_u32 s25, s25, 1024
    s_add_u32 s26, s26, 1024
    s_add_u32 s27, s27, 1024
    v_mfma_f32_16x16x32_bf16 v[104:107], v[164:167], v[192:195], v[104:107]
    v_mfma_f32_16x16x32_bf16 v[128:131], v[168:171], v[192:195], v[128:131]
    v_mfma_f32_16x16x32_bf16 v[152:155], v[172:175], v[192:195], v[152:155]
    v_mfma_f32_16x16x32_bf16 v[84:87], v[160:163], v[196:199], v[84:87]
    v_mfma_f32_16x16x32_bf16 v[108:111], v[164:167], v[196:199], v[108:111]
    v_mfma_f32_16x16x32_bf16 v[132:135], v[168:171], v[196:199], v[132:135]
    v_mfma_f32_16x16x32_bf16 v[156:159], v[172:175], v[196:199], v[156:159]
    s_waitcnt vmcnt(5)
    s_barrier
    s_waitcnt lgkmcnt(0)
    v_mfma_f32_16x16x32_bf16 v[64:67], v[200:203], v[216:219], v[64:67]
    v_mfma_f32_16x16x32_bf16 v[88:91], v[204:207], v[216:219], v[88:91]
    ds_read_b128 v[160:163], v3 offset:40960
    v_mfma_f32_16x16x32_bf16 v[112:115], v[208:211], v[216:219], v[112:115]
    ds_read_b128 v[164:167], v3 offset:41984
    v_mfma_f32_16x16x32_bf16 v[136:139], v[212:215], v[216:219], v[136:139]
    ds_read_b128 v[168:171], v3 offset:45056
    v_mfma_f32_16x16x32_bf16 v[68:71], v[200:203], v[220:223], v[68:71]
    ds_read_b128 v[172:175], v3 offset:46080
    v_mfma_f32_16x16x32_bf16 v[92:95], v[204:207], v[220:223], v[92:95]
    ds_read_b128 v[176:179], v5 offset:40960
    v_mfma_f32_16x16x32_bf16 v[116:119], v[208:211], v[220:223], v[116:119]
    ds_read_b128 v[180:183], v5 offset:41984
    v_mfma_f32_16x16x32_bf16 v[140:143], v[212:215], v[220:223], v[140:143]
    ds_read_b128 v[184:187], v5 offset:43008
    v_mfma_f32_16x16x32_bf16 v[72:75], v[200:203], v[224:227], v[72:75]
    ds_read_b128 v[188:191], v5 offset:44032
    v_mfma_f32_16x16x32_bf16 v[96:99], v[204:207], v[224:227], v[96:99]
    ds_read_b128 v[192:195], v5 offset:45056
    v_mfma_f32_16x16x32_bf16 v[120:123], v[208:211], v[224:227], v[120:123]
    ds_read_b128 v[196:199], v5 offset:46080
    v_mfma_f32_16x16x32_bf16 v[144:147], v[212:215], v[224:227], v[144:147]
    v_mfma_f32_16x16x32_bf16 v[76:79], v[200:203], v[228:231], v[76:79]
    v_mfma_f32_16x16x32_bf16 v[100:103], v[204:207], v[228:231], v[100:103]
    v_mfma_f32_16x16x32_bf16 v[124:127], v[208:211], v[228:231], v[124:127]
    v_mfma_f32_16x16x32_bf16 v[148:151], v[212:215], v[228:231], v[148:151]
    v_mfma_f32_16x16x32_bf16 v[80:83], v[200:203], v[232:235], v[80:83]
    v_mfma_f32_16x16x32_bf16 v[104:107], v[204:207], v[232:235], v[104:107]
    v_mfma_f32_16x16x32_bf16 v[128:131], v[208:211], v[232:235], v[128:131]
    v_mfma_f32_16x16x32_bf16 v[152:155], v[212:215], v[232:235], v[152:155]
    v_mfma_f32_16x16x32_bf16 v[84:87], v[200:203], v[236:239], v[84:87]
    v_mfma_f32_16x16x32_bf16 v[108:111], v[204:207], v[236:239], v[108:111]
    v_mfma_f32_16x16x32_bf16 v[132:135], v[208:211], v[236:239], v[132:135]
    v_mfma_f32_16x16x32_bf16 v[156:159], v[212:215], v[236:239], v[156:159]
    s_waitcnt vmcnt(0)
    s_barrier
    s_waitcnt lgkmcnt(0)
    v_mfma_f32_16x16x32_bf16 v[64:67], v[160:163], v[176:179], v[64:67]
    v_mfma_f32_16x16x32_bf16 v[88:91], v[164:167], v[176:179], v[88:91]
    ds_read_b128 v[200:203], v6 offset:0
    v_mfma_f32_16x16x32_bf16 v[112:115], v[168:171], v[176:179], v[112:115]
    ds_read_b128 v[204:207], v6 offset:1024
    v_mfma_f32_16x16x32_bf16 v[136:139], v[172:175], v[176:179], v[136:139]
    ds_read_b128 v[208:211], v6 offset:4096
    v_mfma_f32_16x16x32_bf16 v[68:71], v[160:163], v[180:183], v[68:71]
    ds_read_b128 v[212:215], v6 offset:5120
    v_mfma_f32_16x16x32_bf16 v[92:95], v[164:167], v[180:183], v[92:95]
    ds_read_b128 v[216:219], v8 offset:0
    v_mfma_f32_16x16x32_bf16 v[116:119], v[168:171], v[180:183], v[116:119]
    ds_read_b128 v[220:223], v8 offset:1024
    v_mfma_f32_16x16x32_bf16 v[140:143], v[172:175], v[180:183], v[140:143]
    ds_read_b128 v[224:227], v8 offset:2048
    v_mfma_f32_16x16x32_bf16 v[72:75], v[160:163], v[184:187], v[72:75]
    ds_read_b128 v[228:231], v8 offset:3072
    v_mfma_f32_16x16x32_bf16 v[96:99], v[164:167], v[184:187], v[96:99]
    ds_read_b128 v[232:235], v8 offset:4096
    v_mfma_f32_16x16x32_bf16 v[120:123], v[168:171], v[184:187], v[120:123]
    ds_read_b128 v[236:239], v8 offset:5120
    v_mfma_f32_16x16x32_bf16 v[144:147], v[172:175], v[184:187], v[144:147]
    v_mfma_f32_16x16x32_bf16 v[76:79], v[160:163], v[188:191], v[76:79]
    v_mfma_f32_16x16x32_bf16 v[100:103], v[164:167], v[188:191], v[100:103]
    v_mfma_f32_16x16x32_bf16 v[124:127], v[168:171], v[188:191], v[124:127]
    v_mfma_f32_16x16x32_bf16 v[148:151], v[172:175], v[188:191], v[148:151]
    v_mfma_f32_16x16x32_bf16 v[80:83], v[160:163], v[192:195], v[80:83]
    v_mfma_f32_16x16x32_bf16 v[104:107], v[164:167], v[192:195], v[104:107]
    v_mfma_f32_16x16x32_bf16 v[128:131], v[168:171], v[192:195], v[128:131]
    v_mfma_f32_16x16x32_bf16 v[152:155], v[172:175], v[192:195], v[152:155]
    v_mfma_f32_16x16x32_bf16 v[84:87], v[160:163], v[196:199], v[84:87]
    v_mfma_f32_16x16x32_bf16 v[108:111], v[164:167], v[196:199], v[108:111]
    v_mfma_f32_16x16x32_bf16 v[132:135], v[168:171], v[196:199], v[132:135]
    v_mfma_f32_16x16x32_bf16 v[156:159], v[172:175], v[196:199], v[156:159]
    s_waitcnt lgkmcnt(0)
    v_mfma_f32_16x16x32_bf16 v[64:67], v[200:203], v[216:219], v[64:67]
    v_mfma_f32_16x16x32_bf16 v[88:91], v[204:207], v[216:219], v[88:91]
    v_mfma_f32_16x16x32_bf16 v[112:115], v[208:211], v[216:219], v[112:115]
    v_mfma_f32_16x16x32_bf16 v[136:139], v[212:215], v[216:219], v[136:139]
    v_mfma_f32_16x16x32_bf16 v[68:71], v[200:203], v[220:223], v[68:71]
    v_mfma_f32_16x16x32_bf16 v[92:95], v[204:207], v[220:223], v[92:95]
    v_mfma_f32_16x16x32_bf16 v[116:119], v[208:211], v[220:223], v[116:119]
    v_mfma_f32_16x16x32_bf16 v[140:143], v[212:215], v[220:223], v[140:143]
    v_mfma_f32_16x16x32_bf16 v[72:75], v[200:203], v[224:227], v[72:75]
    v_mfma_f32_16x16x32_bf16 v[96:99], v[204:207], v[224:227], v[96:99]
    v_mfma_f32_16x16x32_bf16 v[120:123], v[208:211], v[224:227], v[120:123]
    v_mfma_f32_16x16x32_bf16 v[144:147], v[212:215], v[224:227], v[144:147]
    v_mfma_f32_16x16x32_bf16 v[76:79], v[200:203], v[228:231], v[76:79]
    v_mfma_f32_16x16x32_bf16 v[100:103], v[204:207], v[228:231], v[100:103]
    v_mfma_f32_16x16x32_bf16 v[124:127], v[208:211], v[228:231], v[124:127]
    v_mfma_f32_16x16x32_bf16 v[148:151], v[212:215], v[228:231], v[148:151]
    v_mfma_f32_16x16x32_bf16 v[80:83], v[200:203], v[232:235], v[80:83]
    v_mfma_f32_16x16x32_bf16 v[104:107], v[204:207], v[232:235], v[104:107]
    v_mfma_f32_16x16x32_bf16 v[128:131], v[208:211], v[232:235], v[128:131]
    v_mfma_f32_16x16x32_bf16 v[152:155], v[212:215], v[232:235], v[152:155]
    v_mfma_f32_16x16x32_bf16 v[84:87], v[200:203], v[236:239], v[84:87]
    v_mfma_f32_16x16x32_bf16 v[108:111], v[204:207], v[236:239], v[108:111]
    v_mfma_f32_16x16x32_bf16 v[132:135], v[208:211], v[236:239], v[132:135]
    v_mfma_f32_16x16x32_bf16 v[156:159], v[212:215], v[236:239], v[156:159]
    s_lshl_b32 s26, s20, 1
    s_add_u32 s26, s26, s23
    s_cmp_ge_u32 s26, 43
    s_cbranch_scc1 K2_END
    s_mul_i32 s28, s21, 12
    s_mul_i32 s29, s22, 6
    s_add_u32 s28, s28, s29
    s_mul_i32 s28, s28, 43
    s_add_u32 s28, s28, s26
    s_lshl_b32 s28, s28, 10
    v_and_b32 v6, 15, v63
    v_lshlrev_b32 v6, 4, v6
    v_lshrrev_b32 v7, 5, v63
    v_lshl_add_u32 v6, v7, 8, v6
    v_bfe_u32 v7, v63, 4, 1
    v_lshl_add_u32 v6, v7, 3, v6
    s_nop 7
    s_nop 7
    v_cvt_pk_bf16_f32 v8, v64, v65
    v_cvt_pk_bf16_f32 v9, v66, v67
    v_cvt_pk_bf16_f32 v18, v112, v113
    v_cvt_pk_bf16_f32 v19, v114, v115
    v_lshlrev_b32 v10, 16, v8
    v_and_b32 v11, 0xffff0000, v8
    v_lshlrev_b32 v12, 16, v9
    v_and_b32 v13, 0xffff0000, v9
    v_mul_f32 v14, 0xbfb8aa3b, v10
    v_mul_f32 v15, 0xbfb8aa3b, v11
    v_mul_f32 v16, 0xbfb8aa3b, v12
    v_mul_f32 v17, 0xbfb8aa3b, v13
    v_exp_f32 v14, v14
    v_exp_f32 v15, v15
    v_exp_f32 v16, v16
    v_exp_f32 v17, v17
    s_nop 0
    v_add_f32 v14, 1.0, v14
    v_add_f32 v15, 1.0, v15
    v_add_f32 v16, 1.0, v16
    v_add_f32 v17, 1.0, v17
    v_rcp_f32 v20, v14
    v_rcp_f32 v21, v15
    v_rcp_f32 v22, v16
    v_rcp_f32 v23, v17
    s_nop 0
    v_mul_f32 v24, v10, v20
    v_fma_f32 v25, -v24, v14, v10
    v_fma_f32 v10, v25, v20, v24
    v_mul_f32 v24, v11, v21
    v_fma_f32 v25, -v24, v15, v11
    v_fma_f32 v11, v25, v21, v24
    v_mul_f32 v24, v12, v22
    v_fma_f32 v25, -v24, v16, v12
    v_fma_f32 v12, v25, v22, v24
    v_mul_f32 v24, v13, v23
    v_fma_f32 v25, -v24, v17, v13
    v_fma_f32 v13, v25, v23, v24
    v_cvt_pk_bf16_f32 v8, v10, v11
    v_cvt_pk_bf16_f32 v9, v12, v13
    v_lshlrev_b32 v10, 16, v8
    v_and_b32 v11, 0xffff0000, v8
    v_lshlrev_b32 v12, 16, v9
    v_and_b32 v13, 0xffff0000, v9
    v_lshlrev_b32 v14, 16, v18
    v_and_b32 v15, 0xffff0000, v18
    v_lshlrev_b32 v16, 16, v19
    v_and_b32 v17, 0xffff0000, v19
    v_mul_f32 v10, v10, v14
    v_mul_f32 v11, v11, v15
    v_mul_f32 v12, v12, v16
    v_mul_f32 v13, v13, v17
    v_cvt_pk_bf16_f32 v26, v10, v11
    v_cvt_pk_bf16_f32 v27, v12, v13
    buffer_store_dwordx2 v[26:27], v6, s[16:19], s28 offen offset:0
    s_nop 1
    v_cvt_pk_bf16_f32 v8, v88, v89
    v_cvt_pk_bf16_f32 v9, v90, v91
    v_cvt_pk_bf16_f32 v18, v136, v137
    v_cvt_pk_bf16_f32 v19, v138, v139
    v_lshlrev_b32 v10, 16, v8
    v_and_b32 v11, 0xffff0000, v8
    v_lshlrev_b32 v12, 16, v9
    v_and_b32 v13, 0xffff0000, v9
    v_mul_f32 v14, 0xbfb8aa3b, v10
    v_mul_f32 v15, 0xbfb8aa3b, v11
    v_mul_f32 v16, 0xbfb8aa3b, v12
    v_mul_f32 v17, 0xbfb8aa3b, v13
    v_exp_f32 v14, v14
    v_exp_f32 v15, v15
    v_exp_f32 v16, v16
    v_exp_f32 v17, v17
    s_nop 0
    v_add_f32 v14, 1.0, v14
    v_add_f32 v15, 1.0, v15
    v_add_f32 v16, 1.0, v16
    v_add_f32 v17, 1.0, v17
    v_rcp_f32 v20, v14
    v_rcp_f32 v21, v15
    v_rcp_f32 v22, v16
    v_rcp_f32 v23, v17
    s_nop 0
    v_mul_f32 v24, v10, v20
    v_fma_f32 v25, -v24, v14, v10
    v_fma_f32 v10, v25, v20, v24
    v_mul_f32 v24, v11, v21
    v_fma_f32 v25, -v24, v15, v11
    v_fma_f32 v11, v25, v21, v24
    v_mul_f32 v24, v12, v22
    v_fma_f32 v25, -v24, v16, v12
    v_fma_f32 v12, v25, v22, v24
    v_mul_f32 v24, v13, v23
    v_fma_f32 v25, -v24, v17, v13
    v_fma_f32 v13, v25, v23, v24
    v_cvt_pk_bf16_f32 v8, v10, v11
    v_cvt_pk_bf16_f32 v9, v12, v13
    v_lshlrev_b32 v10, 16, v8
    v_and_b32 v11, 0xffff0000, v8
    v_lshlrev_b32 v12, 16, v9
    v_and_b32 v13, 0xffff0000, v9
    v_lshlrev_b32 v14, 16, v18
    v_and_b32 v15, 0xffff0000, v18
    v_lshlrev_b32 v16, 16, v19
    v_and_b32 v17, 0xffff0000, v19
    v_mul_f32 v10, v10, v14
    v_mul_f32 v11, v11, v15
    v_mul_f32 v12, v12, v16
    v_mul_f32 v13, v13, v17
    v_cvt_pk_bf16_f32 v26, v10, v11
    v_cvt_pk_bf16_f32 v27, v12, v13
    buffer_store_dwordx2 v[26:27], v6, s[16:19], s28 offen offset:512
    s_nop 1
    s_add_u32 s28, s28, 44032
    v_cvt_pk_bf16_f32 v8, v68, v69
    v_cvt_pk_bf16_f32 v9, v70, v71
    v_cvt_pk_bf16_f32 v18, v116, v117
    v_cvt_pk_bf16_f32 v19, v118, v119
    v_lshlrev_b32 v10, 16, v8
    v_and_b32 v11, 0xffff0000, v8
    v_lshlrev_b32 v12, 16, v9
    v_and_b32 v13, 0xffff0000, v9
    v_mul_f32 v14, 0xbfb8aa3b, v10
    v_mul_f32 v15, 0xbfb8aa3b, v11
    v_mul_f32 v16, 0xbfb8aa3b, v12
    v_mul_f32 v17, 0xbfb8aa3b, v13
    v_exp_f32 v14, v14
    v_exp_f32 v15, v15
    v_exp_f32 v16, v16
    v_exp_f32 v17, v17
    s_nop 0
    v_add_f32 v14, 1.0, v14
    v_add_f32 v15, 1.0, v15
    v_add_f32 v16, 1.0, v16
    v_add_f32 v17, 1.0, v17
    v_rcp_f32 v20, v14
    v_rcp_f32 v21, v15
    v_rcp_f32 v22, v16
    v_rcp_f32 v23, v17
    s_nop 0
    v_mul_f32 v24, v10, v20
    v_fma_f32 v25, -v24, v14, v10
    v_fma_f32 v10, v25, v20, v24
    v_mul_f32 v24, v11, v21
    v_fma_f32 v25, -v24, v15, v11
    v_fma_f32 v11, v25, v21, v24
    v_mul_f32 v24, v12, v22
    v_fma_f32 v25, -v24, v16, v12
    v_fma_f32 v12, v25, v22, v24
    v_mul_f32 v24, v13, v23
    v_fma_f32 v25, -v24, v17, v13
    v_fma_f32 v13, v25, v23, v24
    v_cvt_pk_bf16_f32 v8, v10, v11
    v_cvt_pk_bf16_f32 v9, v12, v13
    v_lshlrev_b32 v10, 16, v8
    v_and_b32 v11, 0xffff0000, v8
    v_lshlrev_b32 v12, 16, v9
    v_and_b32 v13, 0xffff0000, v9
    v_lshlrev_b32 v14, 16, v18
    v_and_b32 v15, 0xffff0000, v18
    v_lshlrev_b32 v16, 16, v19
    v_and_b32 v17, 0xffff0000, v19
    v_mul_f32 v10, v10, v14
    v_mul_f32 v11, v11, v15
    v_mul_f32 v12, v12, v16
    v_mul_f32 v13, v13, v17
    v_cvt_pk_bf16_f32 v26, v10, v11
    v_cvt_pk_bf16_f32 v27, v12, v13
    buffer_store_dwordx2 v[26:27], v6, s[16:19], s28 offen offset:0
    s_nop 1
    v_cvt_pk_bf16_f32 v8, v92, v93
    v_cvt_pk_bf16_f32 v9, v94, v95
    v_cvt_pk_bf16_f32 v18, v140, v141
    v_cvt_pk_bf16_f32 v19, v142, v143
    v_lshlrev_b32 v10, 16, v8
    v_and_b32 v11, 0xffff0000, v8
    v_lshlrev_b32 v12, 16, v9
    v_and_b32 v13, 0xffff0000, v9
    v_mul_f32 v14, 0xbfb8aa3b, v10
    v_mul_f32 v15, 0xbfb8aa3b, v11
    v_mul_f32 v16, 0xbfb8aa3b, v12
    v_mul_f32 v17, 0xbfb8aa3b, v13
    v_exp_f32 v14, v14
    v_exp_f32 v15, v15
    v_exp_f32 v16, v16
    v_exp_f32 v17, v17
    s_nop 0
    v_add_f32 v14, 1.0, v14
    v_add_f32 v15, 1.0, v15
    v_add_f32 v16, 1.0, v16
    v_add_f32 v17, 1.0, v17
    v_rcp_f32 v20, v14
    v_rcp_f32 v21, v15
    v_rcp_f32 v22, v16
    v_rcp_f32 v23, v17
    s_nop 0
    v_mul_f32 v24, v10, v20
    v_fma_f32 v25, -v24, v14, v10
    v_fma_f32 v10, v25, v20, v24
    v_mul_f32 v24, v11, v21
    v_fma_f32 v25, -v24, v15, v11
    v_fma_f32 v11, v25, v21, v24
    v_mul_f32 v24, v12, v22
    v_fma_f32 v25, -v24, v16, v12
    v_fma_f32 v12, v25, v22, v24
    v_mul_f32 v24, v13, v23
    v_fma_f32 v25, -v24, v17, v13
    v_fma_f32 v13, v25, v23, v24
    v_cvt_pk_bf16_f32 v8, v10, v11
    v_cvt_pk_bf16_f32 v9, v12, v13
    v_lshlrev_b32 v10, 16, v8
    v_and_b32 v11, 0xffff0000, v8
    v_lshlrev_b32 v12, 16, v9
    v_and_b32 v13, 0xffff0000, v9
    v_lshlrev_b32 v14, 16, v18
    v_and_b32 v15, 0xffff0000, v18
    v_lshlrev_b32 v16, 16, v19
    v_and_b32 v17, 0xffff0000, v19
    v_mul_f32 v10, v10, v14
    v_mul_f32 v11, v11, v15
    v_mul_f32 v12, v12, v16
    v_mul_f32 v13, v13, v17
    v_cvt_pk_bf16_f32 v26, v10, v11
    v_cvt_pk_bf16_f32 v27, v12, v13
    buffer_store_dwordx2 v[26:27], v6, s[16:19], s28 offen offset:512
    s_nop 1
    s_add_u32 s28, s28, 44032
    v_cvt_pk_bf16_f32 v8, v72, v73
    v_cvt_pk_bf16_f32 v9, v74, v75
    v_cvt_pk_bf16_f32 v18, v120, v121
    v_cvt_pk_bf16_f32 v19, v122, v123
    v_lshlrev_b32 v10, 16, v8
    v_and_b32 v11, 0xffff0000, v8
    v_lshlrev_b32 v12, 16, v9
    v_and_b32 v13, 0xffff0000, v9
    v_mul_f32 v14, 0xbfb8aa3b, v10
    v_mul_f32 v15, 0xbfb8aa3b, v11
    v_mul_f32 v16, 0xbfb8aa3b, v12
    v_mul_f32 v17, 0xbfb8aa3b, v13
    v_exp_f32 v14, v14
    v_exp_f32 v15, v15
    v_exp_f32 v16, v16
    v_exp_f32 v17, v17
    s_nop 0
    v_add_f32 v14, 1.0, v14
    v_add_f32 v15, 1.0, v15
    v_add_f32 v16, 1.0, v16
    v_add_f32 v17, 1.0, v17
    v_rcp_f32 v20, v14
    v_rcp_f32 v21, v15
    v_rcp_f32 v22, v16
    v_rcp_f32 v23, v17
    s_nop 0
    v_mul_f32 v24, v10, v20
    v_fma_f32 v25, -v24, v14, v10
    v_fma_f32 v10, v25, v20, v24
    v_mul_f32 v24, v11, v21
    v_fma_f32 v25, -v24, v15, v11
    v_fma_f32 v11, v25, v21, v24
    v_mul_f32 v24, v12, v22
    v_fma_f32 v25, -v24, v16, v12
    v_fma_f32 v12, v25, v22, v24
    v_mul_f32 v24, v13, v23
    v_fma_f32 v25, -v24, v17, v13
    v_fma_f32 v13, v25, v23, v24
    v_cvt_pk_bf16_f32 v8, v10, v11
    v_cvt_pk_bf16_f32 v9, v12, v13
    v_lshlrev_b32 v10, 16, v8
    v_and_b32 v11, 0xffff0000, v8
    v_lshlrev_b32 v12, 16, v9
    v_and_b32 v13, 0xffff0000, v9
    v_lshlrev_b32 v14, 16, v18
    v_and_b32 v15, 0xffff0000, v18
    v_lshlrev_b32 v16, 16, v19
    v_and_b32 v17, 0xffff0000, v19
    v_mul_f32 v10, v10, v14
    v_mul_f32 v11, v11, v15
    v_mul_f32 v12, v12, v16
    v_mul_f32 v13, v13, v17
    v_cvt_pk_bf16_f32 v26, v10, v11
    v_cvt_pk_bf16_f32 v27, v12, v13
    buffer_store_dwordx2 v[26:27], v6, s[16:19], s28 offen offset:0
    s_nop 1
    v_cvt_pk_bf16_f32 v8, v96, v97
    v_cvt_pk_bf16_f32 v9, v98, v99
    v_cvt_pk_bf16_f32 v18, v144, v145
    v_cvt_pk_bf16_f32 v19, v146, v147
    v_lshlrev_b32 v10, 16, v8
    v_and_b32 v11, 0xffff0000, v8
    v_lshlrev_b32 v12, 16, v9
    v_and_b32 v13, 0xffff0000, v9
    v_mul_f32 v14, 0xbfb8aa3b, v10
    v_mul_f32 v15, 0xbfb8aa3b, v11
    v_mul_f32 v16, 0xbfb8aa3b, v12
    v_mul_f32 v17, 0xbfb8aa3b, v13
    v_exp_f32 v14, v14
    v_exp_f32 v15, v15
    v_exp_f32 v16, v16
    v_exp_f32 v17, v17
    s_nop 0
    v_add_f32 v14, 1.0, v14
    v_add_f32 v15, 1.0, v15
    v_add_f32 v16, 1.0, v16
    v_add_f32 v17, 1.0, v17
    v_rcp_f32 v20, v14
    v_rcp_f32 v21, v15
    v_rcp_f32 v22, v16
    v_rcp_f32 v23, v17
    s_nop 0
    v_mul_f32 v24, v10, v20
    v_fma_f32 v25, -v24, v14, v10
    v_fma_f32 v10, v25, v20, v24
    v_mul_f32 v24, v11, v21
    v_fma_f32 v25, -v24, v15, v11
    v_fma_f32 v11, v25, v21, v24
    v_mul_f32 v24, v12, v22
    v_fma_f32 v25, -v24, v16, v12
    v_fma_f32 v12, v25, v22, v24
    v_mul_f32 v24, v13, v23
    v_fma_f32 v25, -v24, v17, v13
    v_fma_f32 v13, v25, v23, v24
    v_cvt_pk_bf16_f32 v8, v10, v11
    v_cvt_pk_bf16_f32 v9, v12, v13
    v_lshlrev_b32 v10, 16, v8
    v_and_b32 v11, 0xffff0000, v8
    v_lshlrev_b32 v12, 16, v9
    v_and_b32 v13, 0xffff0000, v9
    v_lshlrev_b32 v14, 16, v18
    v_and_b32 v15, 0xffff0000, v18
    v_lshlrev_b32 v16, 16, v19
    v_and_b32 v17, 0xffff0000, v19
    v_mul_f32 v10, v10, v14
    v_mul_f32 v11, v11, v15
    v_mul_f32 v12, v12, v16
    v_mul_f32 v13, v13, v17
    v_cvt_pk_bf16_f32 v26, v10, v11
    v_cvt_pk_bf16_f32 v27, v12, v13
    buffer_store_dwordx2 v[26:27], v6, s[16:19], s28 offen offset:512
    s_nop 1
    s_add_u32 s28, s28, 44032
    v_cvt_pk_bf16_f32 v8, v76, v77
    v_cvt_pk_bf16_f32 v9, v78, v79
    v_cvt_pk_bf16_f32 v18, v124, v125
    v_cvt_pk_bf16_f32 v19, v126, v127
    v_lshlrev_b32 v10, 16, v8
    v_and_b32 v11, 0xffff0000, v8
    v_lshlrev_b32 v12, 16, v9
    v_and_b32 v13, 0xffff0000, v9
    v_mul_f32 v14, 0xbfb8aa3b, v10
    v_mul_f32 v15, 0xbfb8aa3b, v11
    v_mul_f32 v16, 0xbfb8aa3b, v12
    v_mul_f32 v17, 0xbfb8aa3b, v13
    v_exp_f32 v14, v14
    v_exp_f32 v15, v15
    v_exp_f32 v16, v16
    v_exp_f32 v17, v17
    s_nop 0
    v_add_f32 v14, 1.0, v14
    v_add_f32 v15, 1.0, v15
    v_add_f32 v16, 1.0, v16
    v_add_f32 v17, 1.0, v17
    v_rcp_f32 v20, v14
    v_rcp_f32 v21, v15
    v_rcp_f32 v22, v16
    v_rcp_f32 v23, v17
    s_nop 0
    v_mul_f32 v24, v10, v20
    v_fma_f32 v25, -v24, v14, v10
    v_fma_f32 v10, v25, v20, v24
    v_mul_f32 v24, v11, v21
    v_fma_f32 v25, -v24, v15, v11
    v_fma_f32 v11, v25, v21, v24
    v_mul_f32 v24, v12, v22
    v_fma_f32 v25, -v24, v16, v12
    v_fma_f32 v12, v25, v22, v24
    v_mul_f32 v24, v13, v23
    v_fma_f32 v25, -v24, v17, v13
    v_fma_f32 v13, v25, v23, v24
    v_cvt_pk_bf16_f32 v8, v10, v11
    v_cvt_pk_bf16_f32 v9, v12, v13
    v_lshlrev_b32 v10, 16, v8
    v_and_b32 v11, 0xffff0000, v8
    v_lshlrev_b32 v12, 16, v9
    v_and_b32 v13, 0xffff0000, v9
    v_lshlrev_b32 v14, 16, v18
    v_and_b32 v15, 0xffff0000, v18
    v_lshlrev_b32 v16, 16, v19
    v_and_b32 v17, 0xffff0000, v19
    v_mul_f32 v10, v10, v14
    v_mul_f32 v11, v11, v15
    v_mul_f32 v12, v12, v16
    v_mul_f32 v13, v13, v17
    v_cvt_pk_bf16_f32 v26, v10, v11
    v_cvt_pk_bf16_f32 v27, v12, v13
    buffer_store_dwordx2 v[26:27], v6, s[16:19], s28 offen offset:0
    s_nop 1
    v_cvt_pk_bf16_f32 v8, v100, v101
    v_cvt_pk_bf16_f32 v9, v102, v103
    v_cvt_pk_bf16_f32 v18, v148, v149
    v_cvt_pk_bf16_f32 v19, v150, v151
    v_lshlrev_b32 v10, 16, v8
    v_and_b32 v11, 0xffff0000, v8
    v_lshlrev_b32 v12, 16, v9
    v_and_b32 v13, 0xffff0000, v9
    v_mul_f32 v14, 0xbfb8aa3b, v10
    v_mul_f32 v15, 0xbfb8aa3b, v11
    v_mul_f32 v16, 0xbfb8aa3b, v12
    v_mul_f32 v17, 0xbfb8aa3b, v13
    v_exp_f32 v14, v14
    v_exp_f32 v15, v15
    v_exp_f32 v16, v16
    v_exp_f32 v17, v17
    s_nop 0
    v_add_f32 v14, 1.0, v14
    v_add_f32 v15, 1.0, v15
    v_add_f32 v16, 1.0, v16
    v_add_f32 v17, 1.0, v17
    v_rcp_f32 v20, v14
    v_rcp_f32 v21, v15
    v_rcp_f32 v22, v16
    v_rcp_f32 v23, v17
    s_nop 0
    v_mul_f32 v24, v10, v20
    v_fma_f32 v25, -v24, v14, v10
    v_fma_f32 v10, v25, v20, v24
    v_mul_f32 v24, v11, v21
    v_fma_f32 v25, -v24, v15, v11
    v_fma_f32 v11, v25, v21, v24
    v_mul_f32 v24, v12, v22
    v_fma_f32 v25, -v24, v16, v12
    v_fma_f32 v12, v25, v22, v24
    v_mul_f32 v24, v13, v23
    v_fma_f32 v25, -v24, v17, v13
    v_fma_f32 v13, v25, v23, v24
    v_cvt_pk_bf16_f32 v8, v10, v11
    v_cvt_pk_bf16_f32 v9, v12, v13
    v_lshlrev_b32 v10, 16, v8
    v_and_b32 v11, 0xffff0000, v8
    v_lshlrev_b32 v12, 16, v9
    v_and_b32 v13, 0xffff0000, v9
    v_lshlrev_b32 v14, 16, v18
    v_and_b32 v15, 0xffff0000, v18
    v_lshlrev_b32 v16, 16, v19
    v_and_b32 v17, 0xffff0000, v19
    v_mul_f32 v10, v10, v14
    v_mul_f32 v11, v11, v15
    v_mul_f32 v12, v12, v16
    v_mul_f32 v13, v13, v17
    v_cvt_pk_bf16_f32 v26, v10, v11
    v_cvt_pk_bf16_f32 v27, v12, v13
    buffer_store_dwordx2 v[26:27], v6, s[16:19], s28 offen offset:512
    s_nop 1
    s_add_u32 s28, s28, 44032
    v_cvt_pk_bf16_f32 v8, v80, v81
    v_cvt_pk_bf16_f32 v9, v82, v83
    v_cvt_pk_bf16_f32 v18, v128, v129
    v_cvt_pk_bf16_f32 v19, v130, v131
    v_lshlrev_b32 v10, 16, v8
    v_and_b32 v11, 0xffff0000, v8
    v_lshlrev_b32 v12, 16, v9
    v_and_b32 v13, 0xffff0000, v9
    v_mul_f32 v14, 0xbfb8aa3b, v10
    v_mul_f32 v15, 0xbfb8aa3b, v11
    v_mul_f32 v16, 0xbfb8aa3b, v12
    v_mul_f32 v17, 0xbfb8aa3b, v13
    v_exp_f32 v14, v14
    v_exp_f32 v15, v15
    v_exp_f32 v16, v16
    v_exp_f32 v17, v17
    s_nop 0
    v_add_f32 v14, 1.0, v14
    v_add_f32 v15, 1.0, v15
    v_add_f32 v16, 1.0, v16
    v_add_f32 v17, 1.0, v17
    v_rcp_f32 v20, v14
    v_rcp_f32 v21, v15
    v_rcp_f32 v22, v16
    v_rcp_f32 v23, v17
    s_nop 0
    v_mul_f32 v24, v10, v20
    v_fma_f32 v25, -v24, v14, v10
    v_fma_f32 v10, v25, v20, v24
    v_mul_f32 v24, v11, v21
    v_fma_f32 v25, -v24, v15, v11
    v_fma_f32 v11, v25, v21, v24
    v_mul_f32 v24, v12, v22
    v_fma_f32 v25, -v24, v16, v12
    v_fma_f32 v12, v25, v22, v24
    v_mul_f32 v24, v13, v23
    v_fma_f32 v25, -v24, v17, v13
    v_fma_f32 v13, v25, v23, v24
    v_cvt_pk_bf16_f32 v8, v10, v11
    v_cvt_pk_bf16_f32 v9, v12, v13
    v_lshlrev_b32 v10, 16, v8
    v_and_b32 v11, 0xffff0000, v8
    v_lshlrev_b32 v12, 16, v9
    v_and_b32 v13, 0xffff0000, v9
    v_lshlrev_b32 v14, 16, v18
    v_and_b32 v15, 0xffff0000, v18
    v_lshlrev_b32 v16, 16, v19
    v_and_b32 v17, 0xffff0000, v19
    v_mul_f32 v10, v10, v14
    v_mul_f32 v11, v11, v15
    v_mul_f32 v12, v12, v16
    v_mul_f32 v13, v13, v17
    v_cvt_pk_bf16_f32 v26, v10, v11
    v_cvt_pk_bf16_f32 v27, v12, v13
    buffer_store_dwordx2 v[26:27], v6, s[16:19], s28 offen offset:0
    s_nop 1
    v_cvt_pk_bf16_f32 v8, v104, v105
    v_cvt_pk_bf16_f32 v9, v106, v107
    v_cvt_pk_bf16_f32 v18, v152, v153
    v_cvt_pk_bf16_f32 v19, v154, v155
    v_lshlrev_b32 v10, 16, v8
    v_and_b32 v11, 0xffff0000, v8
    v_lshlrev_b32 v12, 16, v9
    v_and_b32 v13, 0xffff0000, v9
    v_mul_f32 v14, 0xbfb8aa3b, v10
    v_mul_f32 v15, 0xbfb8aa3b, v11
    v_mul_f32 v16, 0xbfb8aa3b, v12
    v_mul_f32 v17, 0xbfb8aa3b, v13
    v_exp_f32 v14, v14
    v_exp_f32 v15, v15
    v_exp_f32 v16, v16
    v_exp_f32 v17, v17
    s_nop 0
    v_add_f32 v14, 1.0, v14
    v_add_f32 v15, 1.0, v15
    v_add_f32 v16, 1.0, v16
    v_add_f32 v17, 1.0, v17
    v_rcp_f32 v20, v14
    v_rcp_f32 v21, v15
    v_rcp_f32 v22, v16
    v_rcp_f32 v23, v17
    s_nop 0
    v_mul_f32 v24, v10, v20
    v_fma_f32 v25, -v24, v14, v10
    v_fma_f32 v10, v25, v20, v24
    v_mul_f32 v24, v11, v21
    v_fma_f32 v25, -v24, v15, v11
    v_fma_f32 v11, v25, v21, v24
    v_mul_f32 v24, v12, v22
    v_fma_f32 v25, -v24, v16, v12
    v_fma_f32 v12, v25, v22, v24
    v_mul_f32 v24, v13, v23
    v_fma_f32 v25, -v24, v17, v13
    v_fma_f32 v13, v25, v23, v24
    v_cvt_pk_bf16_f32 v8, v10, v11
    v_cvt_pk_bf16_f32 v9, v12, v13
    v_lshlrev_b32 v10, 16, v8
    v_and_b32 v11, 0xffff0000, v8
    v_lshlrev_b32 v12, 16, v9
    v_and_b32 v13, 0xffff0000, v9
    v_lshlrev_b32 v14, 16, v18
    v_and_b32 v15, 0xffff0000, v18
    v_lshlrev_b32 v16, 16, v19
    v_and_b32 v17, 0xffff0000, v19
    v_mul_f32 v10, v10, v14
    v_mul_f32 v11, v11, v15
    v_mul_f32 v12, v12, v16
    v_mul_f32 v13, v13, v17
    v_cvt_pk_bf16_f32 v26, v10, v11
    v_cvt_pk_bf16_f32 v27, v12, v13
    buffer_store_dwordx2 v[26:27], v6, s[16:19], s28 offen offset:512
    s_nop 1
    s_add_u32 s28, s28, 44032
    v_cvt_pk_bf16_f32 v8, v84, v85
    v_cvt_pk_bf16_f32 v9, v86, v87
    v_cvt_pk_bf16_f32 v18, v132, v133
    v_cvt_pk_bf16_f32 v19, v134, v135
    v_lshlrev_b32 v10, 16, v8
    v_and_b32 v11, 0xffff0000, v8
    v_lshlrev_b32 v12, 16, v9
    v_and_b32 v13, 0xffff0000, v9
    v_mul_f32 v14, 0xbfb8aa3b, v10
    v_mul_f32 v15, 0xbfb8aa3b, v11
    v_mul_f32 v16, 0xbfb8aa3b, v12
    v_mul_f32 v17, 0xbfb8aa3b, v13
    v_exp_f32 v14, v14
    v_exp_f32 v15, v15
    v_exp_f32 v16, v16
    v_exp_f32 v17, v17
    s_nop 0
    v_add_f32 v14, 1.0, v14
    v_add_f32 v15, 1.0, v15
    v_add_f32 v16, 1.0, v16
    v_add_f32 v17, 1.0, v17
    v_rcp_f32 v20, v14
    v_rcp_f32 v21, v15
    v_rcp_f32 v22, v16
    v_rcp_f32 v23, v17
    s_nop 0
    v_mul_f32 v24, v10, v20
    v_fma_f32 v25, -v24, v14, v10
    v_fma_f32 v10, v25, v20, v24
    v_mul_f32 v24, v11, v21
    v_fma_f32 v25, -v24, v15, v11
    v_fma_f32 v11, v25, v21, v24
    v_mul_f32 v24, v12, v22
    v_fma_f32 v25, -v24, v16, v12
    v_fma_f32 v12, v25, v22, v24
    v_mul_f32 v24, v13, v23
    v_fma_f32 v25, -v24, v17, v13
    v_fma_f32 v13, v25, v23, v24
    v_cvt_pk_bf16_f32 v8, v10, v11
    v_cvt_pk_bf16_f32 v9, v12, v13
    v_lshlrev_b32 v10, 16, v8
    v_and_b32 v11, 0xffff0000, v8
    v_lshlrev_b32 v12, 16, v9
    v_and_b32 v13, 0xffff0000, v9
    v_lshlrev_b32 v14, 16, v18
    v_and_b32 v15, 0xffff0000, v18
    v_lshlrev_b32 v16, 16, v19
    v_and_b32 v17, 0xffff0000, v19
    v_mul_f32 v10, v10, v14
    v_mul_f32 v11, v11, v15
    v_mul_f32 v12, v12, v16
    v_mul_f32 v13, v13, v17
    v_cvt_pk_bf16_f32 v26, v10, v11
    v_cvt_pk_bf16_f32 v27, v12, v13
    buffer_store_dwordx2 v[26:27], v6, s[16:19], s28 offen offset:0
    s_nop 1
    v_cvt_pk_bf16_f32 v8, v108, v109
    v_cvt_pk_bf16_f32 v9, v110, v111
    v_cvt_pk_bf16_f32 v18, v156, v157
    v_cvt_pk_bf16_f32 v19, v158, v159
    v_lshlrev_b32 v10, 16, v8
    v_and_b32 v11, 0xffff0000, v8
    v_lshlrev_b32 v12, 16, v9
    v_and_b32 v13, 0xffff0000, v9
    v_mul_f32 v14, 0xbfb8aa3b, v10
    v_mul_f32 v15, 0xbfb8aa3b, v11
    v_mul_f32 v16, 0xbfb8aa3b, v12
    v_mul_f32 v17, 0xbfb8aa3b, v13
    v_exp_f32 v14, v14
    v_exp_f32 v15, v15
    v_exp_f32 v16, v16
    v_exp_f32 v17, v17
    s_nop 0
    v_add_f32 v14, 1.0, v14
    v_add_f32 v15, 1.0, v15
    v_add_f32 v16, 1.0, v16
    v_add_f32 v17, 1.0, v17
    v_rcp_f32 v20, v14
    v_rcp_f32 v21, v15
    v_rcp_f32 v22, v16
    v_rcp_f32 v23, v17
    s_nop 0
    v_mul_f32 v24, v10, v20
    v_fma_f32 v25, -v24, v14, v10
    v_fma_f32 v10, v25, v20, v24
    v_mul_f32 v24, v11, v21
    v_fma_f32 v25, -v24, v15, v11
    v_fma_f32 v11, v25, v21, v24
    v_mul_f32 v24, v12, v22
    v_fma_f32 v25, -v24, v16, v12
    v_fma_f32 v12, v25, v22, v24
    v_mul_f32 v24, v13, v23
    v_fma_f32 v25, -v24, v17, v13
    v_fma_f32 v13, v25, v23, v24
    v_cvt_pk_bf16_f32 v8, v10, v11
    v_cvt_pk_bf16_f32 v9, v12, v13
    v_lshlrev_b32 v10, 16, v8
    v_and_b32 v11, 0xffff0000, v8
    v_lshlrev_b32 v12, 16, v9
    v_and_b32 v13, 0xffff0000, v9
    v_lshlrev_b32 v14, 16, v18
    v_and_b32 v15, 0xffff0000, v18
    v_lshlrev_b32 v16, 16, v19
    v_and_b32 v17, 0xffff0000, v19
    v_mul_f32 v10, v10, v14
    v_mul_f32 v11, v11, v15
    v_mul_f32 v12, v12, v16
    v_mul_f32 v13, v13, v17
    v_cvt_pk_bf16_f32 v26, v10, v11
    v_cvt_pk_bf16_f32 v27, v12, v13
    buffer_store_dwordx2 v[26:27], v6, s[16:19], s28 offen offset:512
    s_nop 1
K2_END:
    s_endpgm
.section .rodata,"a"
.p2align 6
.amdhsa_kernel k2_gemm1_kernel
  .amdhsa_next_free_vgpr 256
  .amdhsa_next_free_sgpr 96
  .amdhsa_accum_offset 256
  .amdhsa_group_segment_fixed_size 0
  .amdhsa_kernarg_size 104
  .amdhsa_user_sgpr_count 2
  .amdhsa_user_sgpr_kernarg_segment_ptr 1
  .amdhsa_system_sgpr_workgroup_id_x 1
.end_amdhsa_kernel
.text
.globl k3_gemm2_kernel
.p2align 8
.type k3_gemm2_kernel,@function
k3_gemm2_kernel:
    s_load_dwordx2 s[4:5], s[0:1], 96
    s_load_dwordx2 s[6:7], s[0:1], 0
    s_load_dwordx2 s[34:35], s[0:1], 80
    v_lshrrev_b32 v1, 6, v0
    v_and_b32 v63, 63, v0
    s_nop 0
    v_readfirstlane_b32 s30, v1
    s_waitcnt lgkmcnt(0)
    s_cmp_ge_u32 s2, 256
    s_cbranch_scc1 K3_END
    s_add_u32 s8, s4, 4980736
    s_addc_u32 s9, s5, 0
    s_mov_b32 s10, 1409024
    s_mov_b32 s11, 0x00020000
    s_add_u32 s12, s4, 6389760
    s_addc_u32 s13, s5, 0
    s_mov_b32 s14, 5636096
    s_mov_b32 s15, 0x00020000
    s_lshr_b32 s20, s2, 5
    s_and_b32 s21, s2, 7
    s_lshl_b32 s21, s21, 2
    s_bfe_u32 s22, s2, 0x20003
    s_add_u32 s21, s21, s22
    s_mul_i32 s24, s20, 172
    s_add_u32 s24, s24, s30
    s_lshl_b32 s24, s24, 10
    s_mul_i32 s25, s21, 172
    s_add_u32 s25, s25, s30
    s_lshl_b32 s25, s25, 10
    v_lshlrev_b32 v1, 4, v63
    v_add_u32 v2, 44032, v1
    v_add_u32 v3, 88064, v1
    v_add_u32 v4, 132096, v1
    s_mov_b32 s16, s6
    s_mov_b32 s17, s7
    s_mov_b32 s18, 2097152
    s_mov_b32 s19, 0x00020000
    s_add_u32 s36, s4, 0
    s_addc_u32 s37, s5, 0
    s_mov_b32 s38, 2097152
    s_mov_b32 s39, 0x00020000
    s_add_u32 s40, s4, 14123008
    s_addc_u32 s41, s5, 0
    s_mov_b32 s42, 2097152
    s_mov_b32 s43, 0x00020000
    s_mov_b32 s44, s34
    s_mov_b32 s45, s35
    s_mov_b32 s46, 2097152
    s_mov_b32 s47, 0x00020000
    v_and_b32 v6, 15, v63
    v_lshrrev_b32 v7, 4, v63
    v_lshlrev_b32 v8, 10, v6
    v_lshl_add_u32 v8, v7, 3, v8
    s_lshl_b32 s48, s21, 16
    s_lshl_b32 s49, s20, 7
    s_add_u32 s48, s48, s49
    s_lshl_b32 s49, s30, 5
    s_add_u32 s48, s48, s49
    v_lshlrev_b32 v9, 4, v6
    v_lshrrev_b32 v10, 1, v7
    v_lshl_add_u32 v9, v10, 8, v9
    v_and_b32 v10, 1, v7
    v_lshl_add_u32 v9, v10, 3, v9
    s_lshl_b32 s49, s21, 6
    s_lshl_b32 s50, s20, 1
    s_add_u32 s49, s49, s50
    s_lshr_b32 s50, s30, 1
    s_add_u32 s49, s49, s50
    s_lshl_b32 s49, s49, 10
    s_and_b32 s50, s30, 1
    s_lshl_b32 s50, s50, 9
    s_add_u32 s49, s49, s50
    v_lshlrev_b32 v11, 14, v7
    v_lshl_add_u32 v11, v6, 1, v11
    s_lshl_b32 s50, s20, 18
    s_lshl_b32 s51, s30, 16
    s_add_u32 s50, s50, s51
    s_lshl_b32 s51, s21, 7
    s_add_u32 s50, s50, s51
    s_add_u32 s52, s48, 0
    buffer_load_dwordx2 v[224:225], v8, s[16:19], s52 offen
    s_add_u32 s52, s49, 0
    buffer_load_dwordx2 v[226:227], v9, s[36:39], s52 offen
    s_add_u32 s52, s50, 0
    buffer_load_ushort v228, v11, s[40:43], s52 offen
    s_add_u32 s52, s50, 4096
    buffer_load_ushort v229, v11, s[40:43], s52 offen
    s_add_u32 s52, s50, 8192
    buffer_load_ushort v230, v11, s[40:43], s52 offen
    s_add_u32 s52, s50, 12288
    buffer_load_ushort v231, v11, s[40:43], s52 offen
    s_add_u32 s52, s48, 16384
    buffer_load_dwordx2 v[232:233], v8, s[16:19], s52 offen
    s_add_u32 s52, s49, 16384
    buffer_load_dwordx2 v[234:235], v9, s[36:39], s52 offen
    s_add_u32 s52, s50, 32
    buffer_load_ushort v236, v11, s[40:43], s52 offen
    s_add_u32 s52, s50, 4128
    buffer_load_ushort v237, v11, s[40:43], s52 offen
    s_add_u32 s52, s50, 8224
    buffer_load_ushort v238, v11, s[40:43], s52 offen
    s_add_u32 s52, s50, 12320
    buffer_load_ushort v239, v11, s[40:43], s52 offen
    s_add_u32 s52, s48, 32768
    buffer_load_dwordx2 v[240:241], v8, s[16:19], s52 offen
    s_add_u32 s52, s49, 32768
    buffer_load_dwordx2 v[242:243], v9, s[36:39], s52 offen
    s_add_u32 s52, s50, 64
    buffer_load_ushort v244, v11, s[40:43], s52 offen
    s_add_u32 s52, s50, 4160
    buffer_load_ushort v245, v11, s[40:43], s52 offen
    s_add_u32 s52, s50, 8256
    buffer_load_ushort v246, v11, s[40:43], s52 offen
    s_add_u32 s52, s50, 12352
    buffer_load_ushort v247, v11, s[40:43], s52 offen
    s_add_u32 s52, s48, 49152
    buffer_load_dwordx2 v[248:249], v8, s[16:19], s52 offen
    s_add_u32 s52, s49, 49152
    buffer_load_dwordx2 v[250:251], v9, s[36:39], s52 offen
    s_add_u32 s52, s50, 96
    buffer_load_ushort v252, v11, s[40:43], s52 offen
    s_add_u32 s52, s50, 4192
    buffer_load_ushort v253, v11, s[40:43], s52 offen
    s_add_u32 s52, s50, 8288
    buffer_load_ushort v254, v11, s[40:43], s52 offen
    s_add_u32 s52, s50, 12384
    buffer_load_ushort v255, v11, s[40:43], s52 offen
    v_mov_b32 v64, 0
    v_mov_b32 v65, 0
    v_mov_b32 v66, 0
    v_mov_b32 v67, 0
    v_mov_b32 v68, 0
    v_mov_b32 v69, 0
    v_mov_b32 v70, 0
    v_mov_b32 v71, 0
    v_mov_b32 v72, 0
    v_mov_b32 v73, 0
    v_mov_b32 v74, 0
    v_mov_b32 v75, 0
    v_mov_b32 v76, 0
    v_mov_b32 v77, 0
    v_mov_b32 v78, 0
    v_mov_b32 v79, 0
    v_mov_b32 v80, 0
    v_mov_b32 v81, 0
    v_mov_b32 v82, 0
    v_mov_b32 v83, 0
    v_mov_b32 v84, 0
    v_mov_b32 v85, 0
    v_mov_b32 v86, 0
    v_mov_b32 v87, 0
    v_mov_b32 v88, 0
    v_mov_b32 v89, 0
    v_mov_b32 v90, 0
    v_mov_b32 v91, 0
    v_mov_b32 v92, 0
    v_mov_b32 v93, 0
    v_mov_b32 v94, 0
    v_mov_b32 v95, 0
    v_mov_b32 v96, 0
    v_mov_b32 v97, 0
    v_mov_b32 v98, 0
    v_mov_b32 v99, 0
    v_mov_b32 v100, 0
    v_mov_b32 v101, 0
    v_mov_b32 v102, 0
    v_mov_b32 v103, 0
    v_mov_b32 v104, 0
    v_mov_b32 v105, 0
    v_mov_b32 v106, 0
    v_mov_b32 v107, 0
    v_mov_b32 v108, 0
    v_mov_b32 v109, 0
    v_mov_b32 v110, 0
    v_mov_b32 v111, 0
    v_mov_b32 v112, 0
    v_mov_b32 v113, 0
    v_mov_b32 v114, 0
    v_mov_b32 v115, 0
    v_mov_b32 v116, 0
    v_mov_b32 v117, 0
    v_mov_b32 v118, 0
    v_mov_b32 v119, 0
    v_mov_b32 v120, 0
    v_mov_b32 v121, 0
    v_mov_b32 v122, 0
    v_mov_b32 v123, 0
    v_mov_b32 v124, 0
    v_mov_b32 v125, 0
    v_mov_b32 v126, 0
    v_mov_b32 v127, 0
    s_cmp_lt_u32 s30, 3
    s_cselect_b32 s26, 11, 10
    buffer_load_dwordx4 v[128:131], v1, s[8:11], s24 offen
    buffer_load_dwordx4 v[132:135], v2, s[8:11], s24 offen
    buffer_load_dwordx4 v[136:139], v3, s[8:11], s24 offen
    buffer_load_dwordx4 v[140:143], v4, s[8:11], s24 offen
    buffer_load_dwordx4 v[144:147], v1, s[12:15], s25 offen
    buffer_load_dwordx4 v[148:151], v2, s[12:15], s25 offen
    buffer_load_dwordx4 v[152:155], v3, s[12:15], s25 offen
    buffer_load_dwordx4 v[156:159], v4, s[12:15], s25 offen
    s_add_u32 s24, s24, 4096
    s_add_u32 s25, s25, 4096
    buffer_load_dwordx4 v[160:163], v1, s[8:11], s24 offen
    buffer_load_dwordx4 v[164:167], v2, s[8:11], s24 offen
    buffer_load_dwordx4 v[168:171], v3, s[8:11], s24 offen
    buffer_load_dwordx4 v[172:175], v4, s[8:11], s24 offen
    buffer_load_dwordx4 v[176:179], v1, s[12:15], s25 offen
    buffer_load_dwordx4 v[180:183], v2, s[12:15], s25 offen
    buffer_load_dwordx4 v[184:187], v3, s[12:15], s25 offen
    buffer_load_dwordx4 v[188:191], v4, s[12:15], s25 offen
    s_add_u32 s24, s24, 4096
    s_add_u32 s25, s25, 4096
    s_mov_b32 s27, 0
K3_LOOP:
    s_add_u32 s28, s27, 2
    s_cmp_lt_u32 s28, s26
    s_cbranch_scc0 K3_NOLD0
    buffer_load_dwordx4 v[192:195], v1, s[8:11], s24 offen
    buffer_load_dwordx4 v[196:199], v2, s[8:11], s24 offen
    buffer_load_dwordx4 v[200:203], v3, s[8:11], s24 offen
    buffer_load_dwordx4 v[204:207], v4, s[8:11], s24 offen
    buffer_load_dwordx4 v[208:211], v1, s[12:15], s25 offen
    buffer_load_dwordx4 v[212:215], v2, s[12:15], s25 offen
    buffer_load_dwordx4 v[216:219], v3, s[12:15], s25 offen
    buffer_load_dwordx4 v[220:223], v4, s[12:15], s25 offen
    s_add_u32 s24, s24, 4096
    s_add_u32 s25, s25, 4096
    s_waitcnt vmcnt(16)
    s_branch K3_GO0
K3_NOLD0:
    s_waitcnt vmcnt(0)
K3_GO0:
    v_mfma_f32_16x16x32_bf16 v[64:67], v[128:131], v[144:147], v[64:67]
    v_mfma_f32_16x16x32_bf16 v[80:83], v[132:135], v[144:147], v[80:83]
    v_mfma_f32_16x16x32_bf16 v[96:99], v[136:139], v[144:147], v[96:99]
    v_mfma_f32_16x16x32_bf16 v[112:115], v[140:143], v[144:147], v[112:115]
    v_mfma_f32_16x16x32_bf16 v[68:71], v[128:131], v[148:151], v[68:71]
    v_mfma_f32_16x16x32_bf16 v[84:87], v[132:135], v[148:151], v[84:87]
    v_mfma_f32_16x16x32_bf16 v[100:103], v[136:139], v[148:151], v[100:103]
    v_mfma_f32_16x16x32_bf16 v[116:119], v[140:143], v[148:151], v[116:119]
    v_mfma_f32_16x16x32_bf16 v[72:75], v[128:131], v[152:155], v[72:75]
    v_mfma_f32_16x16x32_bf16 v[88:91], v[132:135], v[152:155], v[88:91]
    v_mfma_f32_16x16x32_bf16 v[104:107], v[136:139], v[152:155], v[104:107]
    v_mfma_f32_16x16x32_bf16 v[120:123], v[140:143], v[152:155], v[120:123]
    v_mfma_f32_16x16x32_bf16 v[76:79], v[128:131], v[156:159], v[76:79]
    v_mfma_f32_16x16x32_bf16 v[92:95], v[132:135], v[156:159], v[92:95]
    v_mfma_f32_16x16x32_bf16 v[108:111], v[136:139], v[156:159], v[108:111]
    v_mfma_f32_16x16x32_bf16 v[124:127], v[140:143], v[156:159], v[124:127]
    s_add_u32 s27, s27, 1
    s_cmp_ge_u32 s27, s26
    s_cbranch_scc1 K3_DONE
    s_add_u32 s28, s27, 2
    s_cmp_lt_u32 s28, s26
    s_cbranch_scc0 K3_NOLD1
    buffer_load_dwordx4 v[128:131], v1, s[8:11], s24 offen
    buffer_load_dwordx4 v[132:135], v2, s[8:11], s24 offen
    buffer_load_dwordx4 v[136:139], v3, s[8:11], s24 offen
    buffer_load_dwordx4 v[140:143], v4, s[8:11], s24 offen
    buffer_load_dwordx4 v[144:147], v1, s[12:15], s25 offen
    buffer_load_dwordx4 v[148:151], v2, s[12:15], s25 offen
    buffer_load_dwordx4 v[152:155], v3, s[12:15], s25 offen
    buffer_load_dwordx4 v[156:159], v4, s[12:15], s25 offen
    s_add_u32 s24, s24, 4096
    s_add_u32 s25, s25, 4096
    s_waitcnt vmcnt(16)
    s_branch K3_GO1
K3_NOLD1:
    s_waitcnt vmcnt(0)
K3_GO1:
    v_mfma_f32_16x16x32_bf16 v[64:67], v[160:163], v[176:179], v[64:67]
    v_mfma_f32_16x16x32_bf16 v[80:83], v[164:167], v[176:179], v[80:83]
    v_mfma_f32_16x16x32_bf16 v[96:99], v[168:171], v[176:179], v[96:99]
    v_mfma_f32_16x16x32_bf16 v[112:115], v[172:175], v[176:179], v[112:115]
    v_mfma_f32_16x16x32_bf16 v[68:71], v[160:163], v[180:183], v[68:71]
    v_mfma_f32_16x16x32_bf16 v[84:87], v[164:167], v[180:183], v[84:87]
    v_mfma_f32_16x16x32_bf16 v[100:103], v[168:171], v[180:183], v[100:103]
    v_mfma_f32_16x16x32_bf16 v[116:119], v[172:175], v[180:183], v[116:119]
    v_mfma_f32_16x16x32_bf16 v[72:75], v[160:163], v[184:187], v[72:75]
    v_mfma_f32_16x16x32_bf16 v[88:91], v[164:167], v[184:187], v[88:91]
    v_mfma_f32_16x16x32_bf16 v[104:107], v[168:171], v[184:187], v[104:107]
    v_mfma_f32_16x16x32_bf16 v[120:123], v[172:175], v[184:187], v[120:123]
    v_mfma_f32_16x16x32_bf16 v[76:79], v[160:163], v[188:191], v[76:79]
    v_mfma_f32_16x16x32_bf16 v[92:95], v[164:167], v[188:191], v[92:95]
    v_mfma_f32_16x16x32_bf16 v[108:111], v[168:171], v[188:191], v[108:111]
    v_mfma_f32_16x16x32_bf16 v[124:127], v[172:175], v[188:191], v[124:127]
    s_add_u32 s27, s27, 1
    s_cmp_ge_u32 s27, s26
    s_cbranch_scc1 K3_DONE
    s_add_u32 s28, s27, 2
    s_cmp_lt_u32 s28, s26
    s_cbranch_scc0 K3_NOLD2
    buffer_load_dwordx4 v[160:163], v1, s[8:11], s24 offen
    buffer_load_dwordx4 v[164:167], v2, s[8:11], s24 offen
    buffer_load_dwordx4 v[168:171], v3, s[8:11], s24 offen
    buffer_load_dwordx4 v[172:175], v4, s[8:11], s24 offen
    buffer_load_dwordx4 v[176:179], v1, s[12:15], s25 offen
    buffer_load_dwordx4 v[180:183], v2, s[12:15], s25 offen
    buffer_load_dwordx4 v[184:187], v3, s[12:15], s25 offen
    buffer_load_dwordx4 v[188:191], v4, s[12:15], s25 offen
    s_add_u32 s24, s24, 4096
    s_add_u32 s25, s25, 4096
    s_waitcnt vmcnt(16)
    s_branch K3_GO2
K3_NOLD2:
    s_waitcnt vmcnt(0)
K3_GO2:
    v_mfma_f32_16x16x32_bf16 v[64:67], v[192:195], v[208:211], v[64:67]
    v_mfma_f32_16x16x32_bf16 v[80:83], v[196:199], v[208:211], v[80:83]
    v_mfma_f32_16x16x32_bf16 v[96:99], v[200:203], v[208:211], v[96:99]
    v_mfma_f32_16x16x32_bf16 v[112:115], v[204:207], v[208:211], v[112:115]
    v_mfma_f32_16x16x32_bf16 v[68:71], v[192:195], v[212:215], v[68:71]
    v_mfma_f32_16x16x32_bf16 v[84:87], v[196:199], v[212:215], v[84:87]
    v_mfma_f32_16x16x32_bf16 v[100:103], v[200:203], v[212:215], v[100:103]
    v_mfma_f32_16x16x32_bf16 v[116:119], v[204:207], v[212:215], v[116:119]
    v_mfma_f32_16x16x32_bf16 v[72:75], v[192:195], v[216:219], v[72:75]
    v_mfma_f32_16x16x32_bf16 v[88:91], v[196:199], v[216:219], v[88:91]
    v_mfma_f32_16x16x32_bf16 v[104:107], v[200:203], v[216:219], v[104:107]
    v_mfma_f32_16x16x32_bf16 v[120:123], v[204:207], v[216:219], v[120:123]
    v_mfma_f32_16x16x32_bf16 v[76:79], v[192:195], v[220:223], v[76:79]
    v_mfma_f32_16x16x32_bf16 v[92:95], v[196:199], v[220:223], v[92:95]
    v_mfma_f32_16x16x32_bf16 v[108:111], v[200:203], v[220:223], v[108:111]
    v_mfma_f32_16x16x32_bf16 v[124:127], v[204:207], v[220:223], v[124:127]
    s_add_u32 s27, s27, 1
    s_cmp_ge_u32 s27, s26
    s_cbranch_scc1 K3_DONE
    s_branch K3_LOOP
K3_DONE:
    s_lshl_b32 s26, s30, 14
    v_add_u32 v5, s26, v1
    s_nop 7
    s_nop 7
    ds_write_b128 v5, v[64:67] offset:0
    ds_write_b128 v5, v[68:71] offset:1024
    ds_write_b128 v5, v[72:75] offset:2048
    ds_write_b128 v5, v[76:79] offset:3072
    ds_write_b128 v5, v[80:83] offset:4096
    ds_write_b128 v5, v[84:87] offset:5120
    ds_write_b128 v5, v[88:91] offset:6144
    ds_write_b128 v5, v[92:95] offset:7168
    ds_write_b128 v5, v[96:99] offset:8192
    ds_write_b128 v5, v[100:103] offset:9216
    ds_write_b128 v5, v[104:107] offset:10240
    ds_write_b128 v5, v[108:111] offset:11264
    ds_write_b128 v5, v[112:115] offset:12288
    ds_write_b128 v5, v[116:119] offset:13312
    ds_write_b128 v5, v[120:123] offset:14336
    ds_write_b128 v5, v[124:127] offset:15360
    s_waitcnt lgkmcnt(0)
    s_barrier
    s_lshl_b32 s26, s30, 12
    v_add_u32 v5, s26, v1
    ds_read_b128 v[128:131], v5 offset:0
    ds_read_b128 v[132:135], v5 offset:16384
    ds_read_b128 v[136:139], v5 offset:32768
    ds_read_b128 v[140:143], v5 offset:49152
    ds_read_b128 v[144:147], v5 offset:1024
    ds_read_b128 v[148:151], v5 offset:17408
    ds_read_b128 v[152:155], v5 offset:33792
    ds_read_b128 v[156:159], v5 offset:50176
    ds_read_b128 v[160:163], v5 offset:2048
    ds_read_b128 v[164:167], v5 offset:18432
    ds_read_b128 v[168:171], v5 offset:34816
    ds_read_b128 v[172:175], v5 offset:51200
    ds_read_b128 v[176:179], v5 offset:3072
    ds_read_b128 v[180:183], v5 offset:19456
    ds_read_b128 v[184:187], v5 offset:35840
    ds_read_b128 v[188:191], v5 offset:52224
    s_waitcnt lgkmcnt(0)
    v_add_f32 v128, v128, v132
    v_add_f32 v136, v136, v140
    v_add_f32 v64, v128, v136
    v_add_f32 v129, v129, v133
    v_add_f32 v137, v137, v141
    v_add_f32 v65, v129, v137
    v_add_f32 v130, v130, v134
    v_add_f32 v138, v138, v142
    v_add_f32 v66, v130, v138
    v_add_f32 v131, v131, v135
    v_add_f32 v139, v139, v143
    v_add_f32 v67, v131, v139
    v_add_f32 v144, v144, v148
    v_add_f32 v152, v152, v156
    v_add_f32 v68, v144, v152
    v_add_f32 v145, v145, v149
    v_add_f32 v153, v153, v157
    v_add_f32 v69, v145, v153
    v_add_f32 v146, v146, v150
    v_add_f32 v154, v154, v158
    v_add_f32 v70, v146, v154
    v_add_f32 v147, v147, v151
    v_add_f32 v155, v155, v159
    v_add_f32 v71, v147, v155
    v_add_f32 v160, v160, v164
    v_add_f32 v168, v168, v172
    v_add_f32 v72, v160, v168
    v_add_f32 v161, v161, v165
    v_add_f32 v169, v169, v173
    v_add_f32 v73, v161, v169
    v_add_f32 v162, v162, v166
    v_add_f32 v170, v170, v174
    v_add_f32 v74, v162, v170
    v_add_f32 v163, v163, v167
    v_add_f32 v171, v171, v175
    v_add_f32 v75, v163, v171
    v_add_f32 v176, v176, v180
    v_add_f32 v184, v184, v188
    v_add_f32 v76, v176, v184
    v_add_f32 v177, v177, v181
    v_add_f32 v185, v185, v189
    v_add_f32 v77, v177, v185
    v_add_f32 v178, v178, v182
    v_add_f32 v186, v186, v190
    v_add_f32 v78, v178, v186
    v_add_f32 v179, v179, v183
    v_add_f32 v187, v187, v191
    v_add_f32 v79, v179, v187
    v_lshlrev_b32 v20, 16, v224
    v_and_b32 v21, 0xffff0000, v224
    v_lshlrev_b32 v22, 16, v225
    v_and_b32 v23, 0xffff0000, v225
    v_lshlrev_b32 v24, 16, v226
    v_and_b32 v25, 0xffff0000, v226
    v_lshlrev_b32 v26, 16, v227
    v_and_b32 v27, 0xffff0000, v227
    v_lshlrev_b32 v16, 16, v228
    v_mul_f32 v16, v24, v16
    v_cvt_pk_bf16_f32 v16, v16, v16
    v_lshlrev_b32 v16, 16, v16
    v_add_f32 v16, v20, v16
    v_cvt_pk_bf16_f32 v16, v16, v16
    v_lshlrev_b32 v16, 16, v16
    v_cvt_pk_bf16_f32 v28, v64, v64
    v_lshlrev_b32 v28, 16, v28
    v_add_f32 v16, v16, v28
    v_lshlrev_b32 v17, 16, v229
    v_mul_f32 v17, v25, v17
    v_cvt_pk_bf16_f32 v17, v17, v17
    v_lshlrev_b32 v17, 16, v17
    v_add_f32 v17, v21, v17
    v_cvt_pk_bf16_f32 v17, v17, v17
    v_lshlrev_b32 v17, 16, v17
    v_cvt_pk_bf16_f32 v28, v65, v65
    v_lshlrev_b32 v28, 16, v28
    v_add_f32 v17, v17, v28
    v_lshlrev_b32 v18, 16, v230
    v_mul_f32 v18, v26, v18
    v_cvt_pk_bf16_f32 v18, v18, v18
    v_lshlrev_b32 v18, 16, v18
    v_add_f32 v18, v22, v18
    v_cvt_pk_bf16_f32 v18, v18, v18
    v_lshlrev_b32 v18, 16, v18
    v_cvt_pk_bf16_f32 v28, v66, v66
    v_lshlrev_b32 v28, 16, v28
    v_add_f32 v18, v18, v28
    v_lshlrev_b32 v19, 16, v231
    v_mul_f32 v19, v27, v19
    v_cvt_pk_bf16_f32 v19, v19, v19
    v_lshlrev_b32 v19, 16, v19
    v_add_f32 v19, v23, v19
    v_cvt_pk_bf16_f32 v19, v19, v19
    v_lshlrev_b32 v19, 16, v19
    v_cvt_pk_bf16_f32 v28, v67, v67
    v_lshlrev_b32 v28, 16, v28
    v_add_f32 v19, v19, v28
    v_cvt_pk_bf16_f32 v32, v16, v17
    v_cvt_pk_bf16_f32 v33, v18, v19
    s_add_u32 s52, s48, 0
    buffer_store_dwordx2 v[32:33], v8, s[44:47], s52 offen
    v_lshlrev_b32 v20, 16, v232
    v_and_b32 v21, 0xffff0000, v232
    v_lshlrev_b32 v22, 16, v233
    v_and_b32 v23, 0xffff0000, v233
    v_lshlrev_b32 v24, 16, v234
    v_and_b32 v25, 0xffff0000, v234
    v_lshlrev_b32 v26, 16, v235
    v_and_b32 v27, 0xffff0000, v235
    v_lshlrev_b32 v16, 16, v236
    v_mul_f32 v16, v24, v16
    v_cvt_pk_bf16_f32 v16, v16, v16
    v_lshlrev_b32 v16, 16, v16
    v_add_f32 v16, v20, v16
    v_cvt_pk_bf16_f32 v16, v16, v16
    v_lshlrev_b32 v16, 16, v16
    v_cvt_pk_bf16_f32 v28, v68, v68
    v_lshlrev_b32 v28, 16, v28
    v_add_f32 v16, v16, v28
    v_lshlrev_b32 v17, 16, v237
    v_mul_f32 v17, v25, v17
    v_cvt_pk_bf16_f32 v17, v17, v17
    v_lshlrev_b32 v17, 16, v17
    v_add_f32 v17, v21, v17
    v_cvt_pk_bf16_f32 v17, v17, v17
    v_lshlrev_b32 v17, 16, v17
    v_cvt_pk_bf16_f32 v28, v69, v69
    v_lshlrev_b32 v28, 16, v28
    v_add_f32 v17, v17, v28
    v_lshlrev_b32 v18, 16, v238
    v_mul_f32 v18, v26, v18
    v_cvt_pk_bf16_f32 v18, v18, v18
    v_lshlrev_b32 v18, 16, v18
    v_add_f32 v18, v22, v18
    v_cvt_pk_bf16_f32 v18, v18, v18
    v_lshlrev_b32 v18, 16, v18
    v_cvt_pk_bf16_f32 v28, v70, v70
    v_lshlrev_b32 v28, 16, v28
    v_add_f32 v18, v18, v28
    v_lshlrev_b32 v19, 16, v239
    v_mul_f32 v19, v27, v19
    v_cvt_pk_bf16_f32 v19, v19, v19
    v_lshlrev_b32 v19, 16, v19
    v_add_f32 v19, v23, v19
    v_cvt_pk_bf16_f32 v19, v19, v19
    v_lshlrev_b32 v19, 16, v19
    v_cvt_pk_bf16_f32 v28, v71, v71
    v_lshlrev_b32 v28, 16, v28
    v_add_f32 v19, v19, v28
    v_cvt_pk_bf16_f32 v34, v16, v17
    v_cvt_pk_bf16_f32 v35, v18, v19
    s_add_u32 s52, s48, 16384
    buffer_store_dwordx2 v[34:35], v8, s[44:47], s52 offen
    v_lshlrev_b32 v20, 16, v240
    v_and_b32 v21, 0xffff0000, v240
    v_lshlrev_b32 v22, 16, v241
    v_and_b32 v23, 0xffff0000, v241
    v_lshlrev_b32 v24, 16, v242
    v_and_b32 v25, 0xffff0000, v242
    v_lshlrev_b32 v26, 16, v243
    v_and_b32 v27, 0xffff0000, v243
    v_lshlrev_b32 v16, 16, v244
    v_mul_f32 v16, v24, v16
    v_cvt_pk_bf16_f32 v16, v16, v16
    v_lshlrev_b32 v16, 16, v16
    v_add_f32 v16, v20, v16
    v_cvt_pk_bf16_f32 v16, v16, v16
    v_lshlrev_b32 v16, 16, v16
    v_cvt_pk_bf16_f32 v28, v72, v72
    v_lshlrev_b32 v28, 16, v28
    v_add_f32 v16, v16, v28
    v_lshlrev_b32 v17, 16, v245
    v_mul_f32 v17, v25, v17
    v_cvt_pk_bf16_f32 v17, v17, v17
    v_lshlrev_b32 v17, 16, v17
    v_add_f32 v17, v21, v17
    v_cvt_pk_bf16_f32 v17, v17, v17
    v_lshlrev_b32 v17, 16, v17
    v_cvt_pk_bf16_f32 v28, v73, v73
    v_lshlrev_b32 v28, 16, v28
    v_add_f32 v17, v17, v28
    v_lshlrev_b32 v18, 16, v246
    v_mul_f32 v18, v26, v18
    v_cvt_pk_bf16_f32 v18, v18, v18
    v_lshlrev_b32 v18, 16, v18
    v_add_f32 v18, v22, v18
    v_cvt_pk_bf16_f32 v18, v18, v18
    v_lshlrev_b32 v18, 16, v18
    v_cvt_pk_bf16_f32 v28, v74, v74
    v_lshlrev_b32 v28, 16, v28
    v_add_f32 v18, v18, v28
    v_lshlrev_b32 v19, 16, v247
    v_mul_f32 v19, v27, v19
    v_cvt_pk_bf16_f32 v19, v19, v19
    v_lshlrev_b32 v19, 16, v19
    v_add_f32 v19, v23, v19
    v_cvt_pk_bf16_f32 v19, v19, v19
    v_lshlrev_b32 v19, 16, v19
    v_cvt_pk_bf16_f32 v28, v75, v75
    v_lshlrev_b32 v28, 16, v28
    v_add_f32 v19, v19, v28
    v_cvt_pk_bf16_f32 v36, v16, v17
    v_cvt_pk_bf16_f32 v37, v18, v19
    s_add_u32 s52, s48, 32768
    buffer_store_dwordx2 v[36:37], v8, s[44:47], s52 offen
    v_lshlrev_b32 v20, 16, v248
    v_and_b32 v21, 0xffff0000, v248
    v_lshlrev_b32 v22, 16, v249
    v_and_b32 v23, 0xffff0000, v249
    v_lshlrev_b32 v24, 16, v250
    v_and_b32 v25, 0xffff0000, v250
    v_lshlrev_b32 v26, 16, v251
    v_and_b32 v27, 0xffff0000, v251
    v_lshlrev_b32 v16, 16, v252
    v_mul_f32 v16, v24, v16
    v_cvt_pk_bf16_f32 v16, v16, v16
    v_lshlrev_b32 v16, 16, v16
    v_add_f32 v16, v20, v16
    v_cvt_pk_bf16_f32 v16, v16, v16
    v_lshlrev_b32 v16, 16, v16
    v_cvt_pk_bf16_f32 v28, v76, v76
    v_lshlrev_b32 v28, 16, v28
    v_add_f32 v16, v16, v28
    v_lshlrev_b32 v17, 16, v253
    v_mul_f32 v17, v25, v17
    v_cvt_pk_bf16_f32 v17, v17, v17
    v_lshlrev_b32 v17, 16, v17
    v_add_f32 v17, v21, v17
    v_cvt_pk_bf16_f32 v17, v17, v17
    v_lshlrev_b32 v17, 16, v17
    v_cvt_pk_bf16_f32 v28, v77, v77
    v_lshlrev_b32 v28, 16, v28
    v_add_f32 v17, v17, v28
    v_lshlrev_b32 v18, 16, v254
    v_mul_f32 v18, v26, v18
    v_cvt_pk_bf16_f32 v18, v18, v18
    v_lshlrev_b32 v18, 16, v18
    v_add_f32 v18, v22, v18
    v_cvt_pk_bf16_f32 v18, v18, v18
    v_lshlrev_b32 v18, 16, v18
    v_cvt_pk_bf16_f32 v28, v78, v78
    v_lshlrev_b32 v28, 16, v28
    v_add_f32 v18, v18, v28
    v_lshlrev_b32 v19, 16, v255
    v_mul_f32 v19, v27, v19
    v_cvt_pk_bf16_f32 v19, v19, v19
    v_lshlrev_b32 v19, 16, v19
    v_add_f32 v19, v23, v19
    v_cvt_pk_bf16_f32 v19, v19, v19
    v_lshlrev_b32 v19, 16, v19
    v_cvt_pk_bf16_f32 v28, v79, v79
    v_lshlrev_b32 v28, 16, v28
    v_add_f32 v19, v19, v28
    v_cvt_pk_bf16_f32 v38, v16, v17
    v_cvt_pk_bf16_f32 v39, v18, v19
    s_add_u32 s52, s48, 49152
    buffer_store_dwordx2 v[38:39], v8, s[44:47], s52 offen
K3_END:
    s_endpgm
.section .rodata,"a"
.p2align 6
.amdhsa_kernel k3_gemm2_kernel
  .amdhsa_next_free_vgpr 256
  .amdhsa_next_free_sgpr 96
  .amdhsa_accum_offset 256
  .amdhsa_group_segment_fixed_size 0
  .amdhsa_kernarg_size 104
  .amdhsa_user_sgpr_count 2
  .amdhsa_user_sgpr_kernarg_segment_ptr 1
  .amdhsa_system_sgpr_workgroup_id_x 1
.end_amdhsa_kernel
.text
```
